```python
import torch

def _softmax(x, axis=-1):
    return torch.softmax(x, dim=axis)
def _gelu(x):
    return torch.nn.functional.gelu(x, approximate="tanh")
def _silu(x):
    return torch.nn.functional.silu(x)
def _sigmoid(x):
    return torch.sigmoid(x)
def _layernorm(x, axis=-1, eps=1e-5):
    m = x.mean(dim=axis, keepdim=True)
    v = x.var(dim=axis, keepdim=True, unbiased=False)
    return (x - m) / torch.sqrt(v + eps)
def _scatter_add(tgt, idx, src, axis=0):
    return tgt.clone().index_add_(axis, idx, src)
def _segment_sum(src, seg, n):
    out = torch.zeros((n,) + src.shape[1:], dtype=src.dtype)
    return out.index_add_(0, seg, src)
def _pad(x, pw):
    flat = tuple(v for pair in reversed(pw) for v in pair)
    return torch.nn.functional.pad(x, flat)

kernel_name = 'parallel_sum__ssm_conv_s5__dense_activation_silu__prompt'

def setup_inputs():

    _w = (lambda a: (lambda t: t.to(torch.bfloat16) if t.is_floating_point() else t)(torch.as_tensor(a)))
    def _A_setup():
        B, S, D = 1, 2048, 448
        P = D
        Lambda_re = -0.5 * (lambda _x: torch.exp(torch.as_tensor(_x)))((lambda *s: torch.randn(*s, dtype=torch.bfloat16) * 0.2)(P))
        Lambda_im = (lambda *s: torch.randn(*s, dtype=torch.bfloat16) * 0.8)(P) * 1.0
        B_re = (lambda *s: torch.randn(*s, dtype=torch.bfloat16) * 0.2)(P, D) * (D ** -0.5)
        B_im = (lambda *s: torch.randn(*s, dtype=torch.bfloat16) * 0.2)(P, D) * (D ** -0.5)
        C_re = (lambda *s: torch.randn(*s, dtype=torch.bfloat16) * 0.2)(D, P) * (P ** -0.5)
        C_im = (lambda *s: torch.randn(*s, dtype=torch.bfloat16) * 0.2)(D, P) * (P ** -0.5)
        log_dt = (lambda *s: torch.randn(*s, dtype=torch.bfloat16) * 0.2)(P) * 0.3 - 2.0
        Dskip = (lambda *s: torch.randn(*s, dtype=torch.bfloat16) * 0.05)(D)
        return {
            "x": _w((lambda *s: torch.randn(*s, dtype=torch.bfloat16) * 0.05)(B, S, D)),
            "Lambda_re": _w(Lambda_re),
            "Lambda_im": _w(Lambda_im),
            "B_re": _w(B_re),
            "B_im": _w(B_im),
            "C_re": _w(C_re),
            "C_im": _w(C_im),
            "log_dt": _w(log_dt),
            "Dskip": _w(Dskip),
        }
    _A_in = _A_setup()

    def _B_setup():
        B, S, D, F = 1, 2048, 448, 1792
        return {
            "x": _w((lambda *s: torch.randn(*s, dtype=torch.bfloat16) * 0.05)(B, S, D)),
            "w1": _w((lambda *s: torch.randn(*s, dtype=torch.bfloat16) * 0.8)(D, F) * (D ** -0.5)),
            "w2": _w((lambda *s: torch.randn(*s, dtype=torch.bfloat16) * 0.2)(F, D) * (F ** -0.5)),
        }
    _B_in = _B_setup()

    return {
        "A_x": _A_in["x"],
        "A_Lambda_re": _A_in["Lambda_re"],
        "A_Lambda_im": _A_in["Lambda_im"],
        "A_B_re": _A_in["B_re"],
        "A_B_im": _A_in["B_im"],
        "A_C_re": _A_in["C_re"],
        "A_C_im": _A_in["C_im"],
        "A_log_dt": _A_in["log_dt"],
        "A_Dskip": _A_in["Dskip"],
        "B_x": _B_in["x"],
        "B_w1": _B_in["w1"],
        "B_w2": _B_in["w2"],
    }

def reference(A_x, A_Lambda_re, A_Lambda_im, A_B_re, A_B_im, A_C_re, A_C_im, A_log_dt, A_Dskip, B_x, B_w1, B_w2):
    def _A_ref(x, Lambda_re, Lambda_im, B_re, B_im, C_re, C_im, log_dt, Dskip):
        Bsz, L, H = x.shape
        Lam = Lambda_re + 1j * Lambda_im
        Bmat = B_re + 1j * B_im
        Cmat = C_re + 1j * C_im
        dt = torch.exp(log_dt)
        Lam_bar = torch.exp(dt * Lam)
        B_bar = ((Lam_bar - 1.0) / Lam)[:, None] * Bmat
        Bu = torch.einsum("bld,pd->blp", x + 0j, B_bar)
        h = torch.zeros_like(Bu[:, 0, :])
        hs = []
        for t in range(L):
            h = Lam_bar[None, :] * h + Bu[:, t, :]
            hs.append(h)
        hseq = torch.stack(hs, 1)
        y = 2.0 * torch.einsum("blp,dp->bld", hseq, Cmat).real + x * Dskip[None, None, :]
        return y

    def _B_ref(x, w1, w2):
        h = torch.einsum("bsd,df->bsf", x, w1)
        h = _silu(h)
        out = torch.einsum("bsf,fd->bsd", h, w2)
        return out

    x = A_x
    xn = _layernorm(x, axis=-1)
    return x + _A_ref(xn, A_Lambda_re, A_Lambda_im, A_B_re, A_B_im, A_C_re, A_C_im, A_log_dt, A_Dskip) + _B_ref(xn, B_w1, B_w2)
```

```asm
; @launch grid=(256,1,1) block=(256,1,1) lds=158720
.amdgcn_target "amdgcn-amd-amdhsa--gfx950"
.text
.globl parallel_sum__ssm_conv_s5__dense_activation_silu__prompt_kernel
.p2align 8
.type parallel_sum__ssm_conv_s5__dense_activation_silu__prompt_kernel,@function
parallel_sum__ssm_conv_s5__dense_activation_silu__prompt_kernel:
s_cmp_ge_u32 s2, 256
s_cbranch_scc1 L_done
s_load_dwordx16 s[16:31], s[0:1], 0
s_load_dwordx8 s[32:39], s[0:1], 64
s_load_dwordx4 s[40:43], s[0:1], 96
s_load_dwordx2 s[44:45], s[0:1], 112
v_lshrrev_b32 v1, 6, v0
v_and_b32 v0, 63, v0
s_lshr_b32 s11, s2, 3
v_readfirstlane_b32 s4, v1
s_and_b32 s12, s2, 7
s_cmp_ge_u32 s11, 28
s_cbranch_scc1 L_pretile
s_mul_i32 s13, s11, 37
s_lshr_b32 s13, s13, 8
s_mul_i32 s6, s13, 7
s_sub_u32 s6, s11, s6
s_and_b32 s5, s2, 6
s_lshl_b32 s5, s5, 1
s_add_u32 s5, s5, s13
s_and_b32 s8, s2, 1
v_lshrrev_b32 v34, 3, v0
v_and_b32 v35, 7, v0
v_mul_u32_u24 v2, 896, v34
v_lshl_add_u32 v2, v35, 4, v2
s_lshl_b32 s11, s5, 2
s_add_u32 s11, s11, s4
s_mul_i32 s11, s11, 28672
s_add_u32 s12, s11, 7168
s_add_u32 s13, s11, 14336
s_add_u32 s14, s11, 21504
s_mov_b32 s50, 0x1c0000
s_mov_b32 s51, 0x00020000
s_and_b32 s87, s4, 1
s_lshr_b32 s86, s4, 1
s_lshl_b32 s7, s6, 2
s_add_u32 s7, s7, s87
s_lshl_b32 s92, s8, 1
s_add_u32 s7, s7, s92
v_and_b32 v36, 31, v0
v_and_b32 v37, 30, v0
s_lshl_b32 s92, s7, 5
v_add_u32 v37, s92, v37
s_mov_b32 s54, 0x62000
s_mov_b32 s55, 0x00020000
s_mov_b32 s62, 0x188000
s_mov_b32 s63, 0x00020000
s_lshl_b32 s93, s5, 1
s_add_u32 s93, s93, s86
s_mov_b32 s88, 0x3f803f80
s_mov_b32 s89, 0x3f80
s_mov_b32 s90, 0x3f800000
v_and_b32 v38, 6, v34
v_xor_b32 v38, v38, v35
v_xor_b32 v38, s86, v38
v_mul_u32_u24 v1, 896, v34
v_lshl_add_u32 v5, v38, 4, v1
v_add_u32 v6, 6144, v5
v_lshlrev_b32 v38, 1, v34
v_and_b32 v38, 4, v38
v_xor_b32 v38, v38, v35
v_mul_u32_u24 v1, 3584, v34
v_lshl_add_u32 v9, v38, 4, v1
v_add_u32 v10, 27648, v9
s_mul_i32 s68, s7, 14336
s_lshl_b32 s69, s7, 7
s_mul_i32 s3, s86, 57344
s_add_u32 s69, s69, s3
s_mul_i32 s56, s87, 20480
s_add_u32 s56, s56, 117760
v_lshrrev_b32 v38, 5, v0
v_and_b32 v39, 3, v34
v_lshl_add_u32 v39, v38, 3, v39
s_lshl_b32 s3, s87, 2
v_add_u32 v39, s3, v39
s_lshl_b32 s92, s86, 10
v_mul_u32_u24 v3, 2064, v35
v_lshl_add_u32 v3, v39, 4, v3
v_add_u32 v3, s92, v3
v_mul_u32_u24 v4, 2064, v38
v_lshl_add_u32 v4, v36, 4, v4
v_add_u32 v4, s92, v4
s_lshr_b32 s3, s7, 1
s_lshl_b32 s15, s3, 2
s_add_u32 s15, s15, s4
s_mul_i32 s46, s5, 56
s_add_u32 s46, s46, s15
s_mul_i32 s47, s5, 114688
s_waitcnt lgkmcnt(0)
s_mov_b32 s48, s16
s_mov_b32 s49, s17
s_mul_i32 s92, s15, 2048
s_add_u32 s92, s92, s47
v_lshl_add_u32 v239, v0, 7, s92
v_cmp_gt_u32 s[28:29], 16, v0
s_nop 1
v_cndmask_b32 v239, -1, v239, s[28:29]
buffer_load_dword v252, v239, s[48:51], 0 offen
buffer_load_dwordx4 v[144:147], v2, s[48:51], s11 offen offset:0
buffer_load_dwordx4 v[148:151], v2, s[48:51], s11 offen offset:128
buffer_load_dwordx4 v[152:155], v2, s[48:51], s11 offen offset:256
buffer_load_dwordx4 v[156:159], v2, s[48:51], s11 offen offset:384
buffer_load_dwordx4 v[80:83], v2, s[48:51], s11 offen offset:512
buffer_load_dwordx4 v[160:163], v2, s[48:51], s12 offen offset:0
buffer_load_dwordx4 v[164:167], v2, s[48:51], s12 offen offset:128
s_cmp_ge_u32 s4, 2
s_cselect_b32 s52, s24, s22
s_cselect_b32 s53, s25, s23
s_mov_b32 s60, s36
s_mov_b32 s61, s37
s_lshr_b32 s47, s46, 2
s_lshl_b32 s47, s47, 1
s_add_u32 s47, s47, s87
s_mul_i32 s92, s47, 896
v_lshl_add_u32 v239, v0, 7, s92
v_cmp_gt_u32 s[28:29], 7, v0
s_nop 1
v_cndmask_b32 v239, -1, v239, s[28:29]
buffer_load_dword v252, v239, s[52:55], 0 offen
s_add_u32 s70, s44, 0xe80000
s_addc_u32 s71, s45, 0
s_load_dword s10, s[70:71], 0
s_getpc_b64 s[100:101]
L_pc:
s_lshl_b32 s3, s6, 2
s_add_u32 s3, s3, s4
s_lshl_b32 s3, s3, 10
v_and_b32 v1, 7, v0
v_lshl_add_u32 v1, v1, 7, s3
v_min_u32 v1, L_end-L_pc-4, v1
global_load_dword v252, v1, s[100:101]
s_mov_b32 s80, s38
s_mov_b32 s81, s39
s_mov_b32 s82, 0x188000
s_mov_b32 s83, 0x00020000
global_load_ushort v41, v37, s[18:19]
global_load_ushort v42, v37, s[20:21]
global_load_ushort v43, v37, s[30:31]
s_lshl_b32 s24, s87, 15
s_mul_i32 s92, s86, 768
s_add_u32 s92, s92, 115584
v_lshl_add_u32 v44, v39, 2, s92
s_lshl_b32 s3, s87, 7
s_add_u32 s3, s3, s92
v_lshl_add_u32 v45, v34, 2, s3
v_and_b32 v32, 1, v0
v_bfe_u32 v46, v0, 1, 3
v_bfe_u32 v47, v0, 4, 1
v_lshl_add_u32 v47, v32, 1, v47
v_and_b32 v1, 6, v46
v_or_b32 v1, v1, v32
v_xor_b32 v1, v1, v38
v_lshlrev_b32 v1, 4, v1
v_lshl_add_u32 v1, v46, 7, v1
v_lshl_add_u32 v1, v47, 10, v1
v_add_u32 v13, s56, v1
v_xor_b32 v14, 32, v13
v_xor_b32 v15, 64, v13
v_xor_b32 v16, 96, v13
v_bfe_u32 v46, v0, 2, 2
v_and_b32 v47, 3, v0
v_lshlrev_b32 v1, 3, v47
v_lshl_add_u32 v1, v46, 7, v1
v_lshrrev_b32 v46, 1, v46
v_lshl_add_u32 v1, v46, 6, v1
v_bfe_u32 v46, v0, 4, 1
v_lshl_add_u32 v1, v46, 5, v1
v_lshl_add_u32 v1, v38, 10, v1
v_add_u32 v17, s56, v1
v_xor_b32 v18, 64, v17
v_add_u32 v7, s24, v1
v_xor_b32 v8, 64, v7
s_lshl_b32 s3, s86, 11
s_add_u32 s56, s56, s3
s_add_u32 s24, s24, s3
v_add_u32 v33, 66048, v3
v_lshl_add_u32 v46, v36, 2, s92
v_lshl_add_u32 v47, v38, 7, s92
v_lshlrev_b32 v19, 4, v0
s_lshl_b32 s3, s6, 2
s_add_u32 s3, s3, s4
s_mul_i32 s84, s3, 28672
v_min_u32 v12, 13, v0
s_lshl_b32 s3, s6, 12
s_add_u32 s3, s3, 0x1080000
v_lshl_add_u32 v12, v12, 8, s3
v_lshlrev_b32 v1, 1, v34
v_and_b32 v1, 4, v1
v_xor_b32 v1, v1, v35
v_mul_u32_u24 v11, 896, v34
v_lshl_add_u32 v11, v1, 4, v11
v_add_u32 v37, 7168, v11
s_lshl_b32 s3, s87, 2
s_add_u32 s3, s3, s86
s_mul_i32 s25, s3, 14336
s_lshl_b32 s3, s6, 7
s_add_u32 s25, s25, s3
s_lshr_b32 s3, s7, 1
s_mul_i32 s57, s3, 114688
s_lshl_b32 s27, s3, 11
s_add_u32 s76, s44, 0xb00000
s_addc_u32 s77, s45, 0
s_mov_b32 s78, 0x24c000
s_mov_b32 s79, 0x00020000
s_add_u32 s72, s44, 0xe00000
s_addc_u32 s73, s45, 0
s_mov_b32 s74, 0x2000
s_mov_b32 s75, 0x00020000
s_lshl_b32 s3, s7, 13
s_add_u32 s72, s72, s3
s_addc_u32 s73, s73, 0
buffer_load_dwordx4 v[168:171], v2, s[48:51], s12 offen offset:256
buffer_load_dwordx4 v[172:175], v2, s[48:51], s12 offen offset:384
buffer_load_dwordx4 v[92:95], v2, s[48:51], s12 offen offset:512
buffer_load_dwordx4 v[176:179], v2, s[48:51], s13 offen offset:0
s_waitcnt vmcnt(15)
ds_write_b128 v3, v[144:147] offset:0
v_dot2_f32_bf16 v208, v144, s88, 0
v_dot2_f32_bf16 v210, v144, v144, 0
v_dot2_f32_bf16 v209, v145, s88, 0
v_dot2_f32_bf16 v211, v145, v145, 0
v_dot2_f32_bf16 v208, v146, s88, v208
v_dot2_f32_bf16 v210, v146, v146, v210
v_dot2_f32_bf16 v209, v147, s88, v209
v_dot2_f32_bf16 v211, v147, v147, v211
s_waitcnt vmcnt(14)
s_nop 0
ds_write_b128 v3, v[148:151] offset:16512
v_dot2_f32_bf16 v208, v148, s88, v208
v_dot2_f32_bf16 v210, v148, v148, v210
v_dot2_f32_bf16 v209, v149, s88, v209
v_dot2_f32_bf16 v211, v149, v149, v211
v_dot2_f32_bf16 v208, v150, s88, v208
v_dot2_f32_bf16 v210, v150, v150, v210
v_dot2_f32_bf16 v209, v151, s88, v209
v_dot2_f32_bf16 v211, v151, v151, v211
s_waitcnt vmcnt(13)
s_nop 0
ds_write_b128 v3, v[152:155] offset:33024
v_dot2_f32_bf16 v208, v152, s88, v208
v_dot2_f32_bf16 v210, v152, v152, v210
v_dot2_f32_bf16 v209, v153, s88, v209
v_dot2_f32_bf16 v211, v153, v153, v211
v_dot2_f32_bf16 v208, v154, s88, v208
v_dot2_f32_bf16 v210, v154, v154, v210
v_dot2_f32_bf16 v209, v155, s88, v209
v_dot2_f32_bf16 v211, v155, v155, v211
s_waitcnt vmcnt(12)
s_nop 0
ds_write_b128 v3, v[156:159] offset:49536
v_dot2_f32_bf16 v208, v156, s88, v208
v_dot2_f32_bf16 v210, v156, v156, v210
v_dot2_f32_bf16 v209, v157, s88, v209
v_dot2_f32_bf16 v211, v157, v157, v211
v_dot2_f32_bf16 v208, v158, s88, v208
v_dot2_f32_bf16 v210, v158, v158, v210
v_dot2_f32_bf16 v209, v159, s88, v209
v_dot2_f32_bf16 v211, v159, v159, v211
s_waitcnt vmcnt(4)
v_lshlrev_b32 v41, 16, v41
v_lshlrev_b32 v42, 16, v42
v_lshlrev_b32 v43, 16, v43
v_mul_f32 v43, 0x3fb8aa3b, v43
v_exp_f32 v43, v43
s_nop 0
v_cvt_pk_bf16_f32 v43, v43, v43
v_and_b32 v43, 0xffff0000, v43
buffer_load_dwordx4 v[180:183], v2, s[48:51], s13 offen offset:128
ds_write_b128 v33, v[80:83] offset:0
v_dot2_f32_bf16 v208, v80, s88, v208
v_dot2_f32_bf16 v210, v80, v80, v210
v_dot2_f32_bf16 v209, v81, s88, v209
v_dot2_f32_bf16 v211, v81, v81, v211
v_dot2_f32_bf16 v208, v82, s88, v208
v_dot2_f32_bf16 v210, v82, v82, v210
v_dot2_f32_bf16 v209, v83, s88, v209
v_dot2_f32_bf16 v211, v83, v83, v211
v_mul_f32 v41, v41, v43
v_mul_f32 v42, v42, v43
v_mul_f32 v41, 0x3fb8aa3b, v41
v_mul_f32 v42, 0x3e22f983, v42
v_and_b32 v31, 1, v0
v_lshl_add_u32 v30, v38, 1, v31
v_cvt_f32_u32 v30, v30
v_lshlrev_b32 v31, 31, v31
buffer_load_dwordx4 v[184:187], v2, s[48:51], s13 offen offset:256
ds_write_b128 v3, v[160:163] offset:256
v_dot2_f32_bf16 v212, v160, s88, 0
v_dot2_f32_bf16 v214, v160, v160, 0
v_dot2_f32_bf16 v213, v161, s88, 0
v_dot2_f32_bf16 v215, v161, v161, 0
v_dot2_f32_bf16 v212, v162, s88, v212
v_dot2_f32_bf16 v214, v162, v162, v214
v_dot2_f32_bf16 v213, v163, s88, v213
v_dot2_f32_bf16 v215, v163, v163, v215
v_xor_b32 v31, 0x80000000, v31
v_exp_f32 v43, v41
v_fract_f32 v21, v42
v_cos_f32 v20, v21
v_sin_f32 v21, v21
v_mul_f32 v20, v20, v43
v_mul_f32 v21, v21, v43
v_xor_b32_e64 v21, v31, v21
buffer_load_dwordx4 v[188:191], v2, s[48:51], s13 offen offset:384
ds_write_b128 v3, v[164:167] offset:16768
v_dot2_f32_bf16 v212, v164, s88, v212
v_dot2_f32_bf16 v214, v164, v164, v214
v_dot2_f32_bf16 v213, v165, s88, v213
v_dot2_f32_bf16 v215, v165, v165, v215
v_dot2_f32_bf16 v212, v166, s88, v212
v_dot2_f32_bf16 v214, v166, v166, v214
v_dot2_f32_bf16 v213, v167, s88, v213
v_dot2_f32_bf16 v215, v167, v167, v215
v_mul_f32 v43, 0x41800000, v41
v_mul_f32 v23, 0x41800000, v42
v_exp_f32 v43, v43
v_fract_f32 v23, v23
v_cos_f32 v22, v23
v_sin_f32 v23, v23
v_mul_f32 v22, v22, v43
v_mul_f32 v23, v23, v43
buffer_load_dwordx4 v[104:107], v2, s[48:51], s13 offen offset:512
buffer_load_dwordx4 v[192:195], v2, s[48:51], s14 offen offset:0
buffer_load_dwordx4 v[196:199], v2, s[48:51], s14 offen offset:128
buffer_load_dwordx4 v[200:203], v2, s[48:51], s14 offen offset:256
s_mul_i32 s92, s46, 1792
v_lshl_add_u32 v239, v0, 7, s92
v_cmp_gt_u32 s[28:29], 14, v0
s_nop 1
v_cndmask_b32 v239, -1, v239, s[28:29]
buffer_load_dword v252, v239, s[60:63], 0 offen
buffer_load_dwordx4 v[204:207], v2, s[48:51], s14 offen offset:384
s_waitcnt vmcnt(12)
ds_write_b128 v3, v[168:171] offset:33280
v_dot2_f32_bf16 v212, v168, s88, v212
v_dot2_f32_bf16 v214, v168, v168, v214
v_dot2_f32_bf16 v213, v169, s88, v213
v_dot2_f32_bf16 v215, v169, v169, v215
v_dot2_f32_bf16 v212, v170, s88, v212
v_dot2_f32_bf16 v214, v170, v170, v214
v_dot2_f32_bf16 v213, v171, s88, v213
v_dot2_f32_bf16 v215, v171, v171, v215
v_xor_b32 v23, v31, v23
v_mul_f32 v43, 0x42000000, v41
v_mul_f32 v25, 0x42000000, v42
v_exp_f32 v43, v43
v_fract_f32 v25, v25
v_cos_f32 v24, v25
v_sin_f32 v25, v25
v_mul_f32_e64 v24, v24, v43
buffer_load_dwordx4 v[116:119], v2, s[48:51], s14 offen offset:512
s_waitcnt vmcnt(12)
ds_write_b128 v3, v[172:175] offset:49792
v_dot2_f32_bf16 v212, v172, s88, v212
v_dot2_f32_bf16 v214, v172, v172, v214
v_dot2_f32_bf16 v213, v173, s88, v213
v_dot2_f32_bf16 v215, v173, v173, v215
v_dot2_f32_bf16 v212, v174, s88, v212
v_dot2_f32_bf16 v214, v174, v174, v214
v_dot2_f32_bf16 v213, v175, s88, v213
v_dot2_f32_bf16 v215, v175, v175, v215
v_mul_f32 v25, v25, v43
v_xor_b32 v25, v31, v25
v_mul_f32 v43, 0x43800000, v41
v_mul_f32 v27, 0x43800000, v42
v_exp_f32 v43, v43
v_fract_f32 v27, v27
v_cos_f32 v26, v27
v_sin_f32_e64 v27, v27
s_add_u32 m0, s56, 0
s_nop 0
buffer_load_dwordx4 v5, s[52:55], s68 offen offset:0 lds
s_waitcnt vmcnt(12)
ds_write_b128 v33, v[92:95] offset:256
v_dot2_f32_bf16 v212, v92, s88, v212
v_dot2_f32_bf16 v214, v92, v92, v214
v_dot2_f32_bf16 v213, v93, s88, v213
v_dot2_f32_bf16 v215, v93, v93, v215
v_dot2_f32_bf16 v212, v94, s88, v212
v_dot2_f32_bf16 v214, v94, v94, v214
v_dot2_f32_bf16 v213, v95, s88, v213
v_dot2_f32_bf16 v215, v95, v95, v215
v_mul_f32 v26, v26, v43
v_mul_f32 v27, v27, v43
v_mul_f32 v41, v41, v30
v_mul_f32 v42, v42, v30
v_mul_f32 v43, 0x42800000, v41
v_mul_f32 v29, 0x42800000, v42
v_exp_f32 v43, v43
v_fract_f32_e64 v29, v29
buffer_load_dwordx4 v6, s[52:55], s68 offen offset:1024 lds
s_add_u32 s68, s68, 128
s_waitcnt vmcnt(12)
ds_write_b128 v3, v[176:179] offset:512
v_dot2_f32_bf16 v216, v176, s88, 0
v_dot2_f32_bf16 v218, v176, v176, 0
v_dot2_f32_bf16 v217, v177, s88, 0
v_dot2_f32_bf16 v219, v177, v177, 0
v_dot2_f32_bf16 v216, v178, s88, v216
v_dot2_f32_bf16 v218, v178, v178, v218
v_dot2_f32_bf16 v217, v179, s88, v217
v_dot2_f32_bf16 v219, v179, v179, v219
v_cos_f32 v28, v29
v_sin_f32 v29, v29
v_mul_f32 v28, v28, v43
v_mul_f32 v29, v29, v43
s_waitcnt lgkmcnt(0)
s_add_u32 s10, s10, 2
s_or_b32 s9, s10, 1
v_mov_b32 v40, s9
s_add_u32 m0, s56, 4096
s_nop 0
buffer_load_dwordx4 v5, s[52:55], s68 offen offset:0 lds
s_waitcnt vmcnt(12)
ds_write_b128 v3, v[180:183] offset:17024
v_dot2_f32_bf16 v216, v180, s88, v216
v_dot2_f32_bf16 v218, v180, v180, v218
v_dot2_f32_bf16 v217, v181, s88, v217
v_dot2_f32_bf16 v219, v181, v181, v219
v_dot2_f32_bf16 v216, v182, s88, v216
v_dot2_f32_bf16 v218, v182, v182, v218
v_dot2_f32_bf16 v217, v183, s88, v217
v_dot2_f32_bf16 v219, v183, v183, v219
v_and_b32_e64 v1, 1, v0
v_mul_u32_u24 v1, 7168, v1
v_bfe_u32 v32, v0, 4, 1
v_lshl_add_u32 v1, v32, 7, v1
v_bfe_u32 v32, v0, 1, 3
v_lshl_add_u32 v1, v32, 3, v1
s_lshl_b32 s3, s7, 8
s_add_u32 s3, s3, 0x1110000
buffer_load_dwordx4 v6, s[52:55], s68 offen offset:1024 lds
s_add_u32 s68, s68, 128
s_waitcnt vmcnt(12)
ds_write_b128 v3, v[184:187] offset:33536
v_dot2_f32_bf16 v216, v184, s88, v216
v_dot2_f32_bf16 v218, v184, v184, v218
v_dot2_f32_bf16 v217, v185, s88, v217
v_dot2_f32_bf16 v219, v185, v185, v219
v_dot2_f32_bf16 v216, v186, s88, v216
v_dot2_f32_bf16 v218, v186, v186, v218
v_dot2_f32_bf16 v217, v187, s88, v217
v_dot2_f32_bf16 v219, v187, v187, v219
v_add_u32 v32, s3, v1
v_mov_b32 v241, 0
v_mov_b32 v242, 0
v_mov_b32 v243, 0
v_mov_b32 v245, 0
v_mov_b32 v246, 0
v_mov_b32 v247, 0
v_mov_b32 v249, 0
s_add_u32 m0, s56, 8192
s_nop 0
buffer_load_dwordx4 v5, s[52:55], s68 offen offset:0 lds
s_waitcnt vmcnt(12)
ds_write_b128 v3, v[188:191] offset:50048
v_dot2_f32_bf16 v216, v188, s88, v216
v_dot2_f32_bf16 v218, v188, v188, v218
v_dot2_f32_bf16 v217, v189, s88, v217
v_dot2_f32_bf16 v219, v189, v189, v219
v_dot2_f32_bf16 v216, v190, s88, v216
v_dot2_f32_bf16 v218, v190, v190, v218
v_dot2_f32_bf16 v217, v191, s88, v217
v_dot2_f32_bf16 v219, v191, v191, v219
v_mov_b32 v250, 0
v_mov_b32 v251, 0
v_mov_b32 v253, 0
v_mov_b32 v254, 0
v_mov_b32 v255, 0
buffer_load_dwordx4 v6, s[52:55], s68 offen offset:1024 lds
s_add_u32 s68, s68, 128
s_waitcnt vmcnt(12)
ds_write_b128 v33, v[104:107] offset:512
v_dot2_f32_bf16 v216, v104, s88, v216
v_dot2_f32_bf16 v218, v104, v104, v218
v_dot2_f32_bf16 v217, v105, s88, v217
v_dot2_f32_bf16 v219, v105, v105, v219
v_dot2_f32_bf16 v216, v106, s88, v216
v_dot2_f32_bf16 v218, v106, v106, v218
v_dot2_f32_bf16 v217, v107, s88, v217
v_dot2_f32_bf16 v219, v107, v107, v219
buffer_load_dwordx4 v[84:87], v2, s[48:51], s11 offen offset:640
s_waitcnt vmcnt(12)
s_nop 0
ds_write_b128 v3, v[192:195] offset:768
v_dot2_f32_bf16 v220, v192, s88, 0
v_dot2_f32_bf16 v222, v192, v192, 0
v_dot2_f32_bf16 v221, v193, s88, 0
v_dot2_f32_bf16 v223, v193, v193, 0
v_dot2_f32_bf16 v220, v194, s88, v220
v_dot2_f32_bf16 v222, v194, v194, v222
v_dot2_f32_bf16 v221, v195, s88, v221
v_dot2_f32_bf16 v223, v195, v195, v223
buffer_load_dwordx4 v[88:91], v2, s[48:51], s11 offen offset:768
s_waitcnt vmcnt(12)
s_nop 0
ds_write_b128 v3, v[196:199] offset:17280
v_dot2_f32_bf16 v220, v196, s88, v220
v_dot2_f32_bf16 v222, v196, v196, v222
v_dot2_f32_bf16 v221, v197, s88, v221
v_dot2_f32_bf16 v223, v197, v197, v223
v_dot2_f32_bf16 v220, v198, s88, v220
v_dot2_f32_bf16 v222, v198, v198, v222
v_dot2_f32_bf16 v221, v199, s88, v221
v_dot2_f32_bf16 v223, v199, v199, v223
buffer_load_dwordx4 v[96:99], v2, s[48:51], s12 offen offset:640
s_waitcnt vmcnt(12)
s_nop 0
ds_write_b128 v3, v[200:203] offset:33792
v_dot2_f32_bf16 v220, v200, s88, v220
v_dot2_f32_bf16 v222, v200, v200, v222
v_dot2_f32_bf16 v221, v201, s88, v221
v_dot2_f32_bf16 v223, v201, v201, v223
v_dot2_f32_bf16 v220, v202, s88, v220
v_dot2_f32_bf16 v222, v202, v202, v222
v_dot2_f32_bf16 v221, v203, s88, v221
v_dot2_f32_bf16 v223, v203, v203, v223
buffer_load_dwordx4 v[100:103], v2, s[48:51], s12 offen offset:768
buffer_load_dwordx4 v[108:111], v2, s[48:51], s13 offen offset:640
s_waitcnt vmcnt(12)
s_nop 0
ds_write_b128 v3, v[204:207] offset:50304
v_dot2_f32_bf16 v220, v204, s88, v220
v_dot2_f32_bf16 v222, v204, v204, v222
v_dot2_f32_bf16 v221, v205, s88, v221
v_dot2_f32_bf16 v223, v205, v205, v223
v_dot2_f32_bf16 v220, v206, s88, v220
v_dot2_f32_bf16 v222, v206, v206, v222
v_dot2_f32_bf16 v221, v207, s88, v221
v_dot2_f32_bf16 v223, v207, v207, v223
buffer_load_dwordx4 v[112:115], v2, s[48:51], s13 offen offset:768
s_waitcnt vmcnt(12)
s_nop 0
ds_write_b128 v33, v[116:119] offset:768
v_dot2_f32_bf16 v220, v116, s88, v220
v_dot2_f32_bf16 v222, v116, v116, v222
v_dot2_f32_bf16 v221, v117, s88, v221
v_dot2_f32_bf16 v223, v117, v117, v223
v_dot2_f32_bf16 v220, v118, s88, v220
v_dot2_f32_bf16 v222, v118, v118, v222
v_dot2_f32_bf16 v221, v119, s88, v221
v_dot2_f32_bf16 v223, v119, v119, v223
buffer_load_dwordx4 v[120:123], v2, s[48:51], s14 offen offset:640
buffer_load_dwordx4 v[124:127], v2, s[48:51], s14 offen offset:768
s_waitcnt lgkmcnt(0)
s_waitcnt vmcnt(8)
s_barrier
s_nop 0
v_add_u32 v3, 66048, v4
ds_read_b128 a[0:3], v4 offset:0
ds_read_b128 a[4:7], v4 offset:512
ds_read_b128 v[144:147], v13 offset:0
ds_read_b128 a[8:11], v4 offset:4128
ds_read_b128 a[12:15], v4 offset:4640
ds_read_b128 v[148:151], v14 offset:0
ds_read_b128 a[16:19], v4 offset:8256
ds_read_b128 a[20:23], v4 offset:8768
ds_read_b128 v[152:155], v15 offset:0
s_waitcnt lgkmcnt(6)
v_mfma_f32_32x32x16_bf16 v[48:63], a[0:3], v[144:147], 0
s_mul_i32 s92, s46, 1792
v_lshl_add_u32 v239, v0, 7, s92
v_cmp_gt_u32 s[28:29], 14, v0
s_nop 1
v_cndmask_b32 v239, -1, v239, s[28:29]
buffer_load_dword v252, v239, s[80:83], 0 offen
s_add_u32 m0, s56, 12288
s_nop 0
buffer_load_dwordx4 v5, s[52:55], s68 offen offset:0 lds
ds_read_b128 a[24:27], v4 offset:12384
s_waitcnt vmcnt(9)
ds_write_b128 v33, v[84:87] offset:16512
v_dot2_f32_bf16 v208, v84, s88, v208
v_dot2_f32_bf16 v210, v84, v84, v210
v_dot2_f32_bf16 v209, v85, s88, v209
v_dot2_f32_bf16 v211, v85, v85, v211
v_mfma_f32_32x32x16_bf16 v[64:79], a[4:7], v[144:147], 0
ds_read_b128 a[28:31], v4 offset:12896
ds_read_b128 a[32:35], v4 offset:16512
ds_read_b128 a[36:39], v4 offset:17024
ds_read_b128 v[156:159], v16 offset:0
v_dot2_f32_bf16 v208, v86, s88, v208
v_dot2_f32_bf16 v210, v86, v86, v210
v_dot2_f32_bf16 v209, v87, s88, v209
v_dot2_f32_bf16 v211, v87, v87, v211
s_waitcnt lgkmcnt(9)
v_mfma_f32_32x32x16_bf16 v[48:63], a[8:11], v[148:151], v[48:63]
buffer_load_dwordx4 v6, s[52:55], s68 offen offset:1024 lds
s_add_u32 s68, s68, 128
ds_read_b128 a[40:43], v4 offset:20640
s_waitcnt vmcnt(9)
ds_write_b128 v33, v[88:91] offset:33024
v_dot2_f32_bf16 v208, v88, s88, v208
v_dot2_f32_bf16 v210, v88, v88, v210
v_dot2_f32_bf16 v209, v89, s88, v209
v_dot2_f32_bf16 v211, v89, v89, v211
v_mfma_f32_32x32x16_bf16 v[64:79], a[12:15], v[148:151], v[64:79]
ds_read_b128 a[44:47], v4 offset:21152
ds_read_b128 a[48:51], v4 offset:24768
ds_read_b128 a[52:55], v4 offset:25280
ds_read_b128 v[144:147], v13 offset:4096
v_dot2_f32_bf16 v208, v90, s88, v208
v_dot2_f32_bf16 v210, v90, v90, v210
v_dot2_f32_bf16 v209, v91, s88, v209
v_dot2_f32_bf16 v211, v91, v91, v211
s_waitcnt lgkmcnt(12)
v_mfma_f32_32x32x16_bf16 v[48:63], a[16:19], v[152:155], v[48:63]
ds_read_b128 a[56:59], v4 offset:28896
s_waitcnt vmcnt(8)
ds_write_b128 v33, v[96:99] offset:16768
v_dot2_f32_bf16 v212, v96, s88, v212
v_dot2_f32_bf16 v214, v96, v96, v214
v_dot2_f32_bf16 v213, v97, s88, v213
v_dot2_f32_bf16 v215, v97, v97, v215
v_mfma_f32_32x32x16_bf16 v[64:79], a[20:23], v[152:155], v[64:79]
ds_read_b128 a[60:63], v4 offset:29408
ds_read_b128 a[64:67], v4 offset:33024
ds_read_b128 v[148:151], v14 offset:4096
v_dot2_f32_bf16 v212, v98, s88, v212
v_dot2_f32_bf16 v214, v98, v98, v214
v_dot2_f32_bf16 v213, v99, s88, v213
v_dot2_f32_bf16 v215, v99, v99, v215
s_waitcnt lgkmcnt(11)
v_mfma_f32_32x32x16_bf16 v[48:63], a[24:27], v[156:159], v[48:63]
s_add_u32 m0, s56, 16384
s_nop 0
buffer_load_dwordx4 v5, s[52:55], s68 offen offset:0 lds
ds_read_b128 a[68:71], v4 offset:33536
s_waitcnt vmcnt(8)
s_nop 0
ds_write_b128 v33, v[100:103] offset:33280
v_dot2_f32_bf16 v212, v100, s88, v212
v_dot2_f32_bf16 v214, v100, v100, v214
v_dot2_f32_bf16 v213, v101, s88, v213
v_dot2_f32_bf16 v215, v101, v101, v215
v_mfma_f32_32x32x16_bf16 v[64:79], a[28:31], v[156:159], v[64:79]
ds_read_b128 a[72:75], v4 offset:37152
ds_read_b128 a[76:79], v4 offset:37664
ds_read_b128 v[152:155], v15 offset:4096
v_dot2_f32_bf16 v212, v102, s88, v212
v_dot2_f32_bf16 v214, v102, v102, v214
v_dot2_f32_bf16 v213, v103, s88, v213
v_dot2_f32_bf16 v215, v103, v103, v215
s_waitcnt lgkmcnt(10)
v_mfma_f32_32x32x16_bf16 v[48:63], a[32:35], v[144:147], v[48:63]
buffer_load_dwordx4 v6, s[52:55], s68 offen offset:1024 lds
s_add_u32 s68, s68, 128
ds_read_b128 a[80:83], v4 offset:41280
s_waitcnt vmcnt(8)
ds_write_b128 v33, v[108:111] offset:17024
v_dot2_f32_bf16 v216, v108, s88, v216
v_dot2_f32_bf16 v218, v108, v108, v218
v_dot2_f32_bf16 v217, v109, s88, v217
v_dot2_f32_bf16 v219, v109, v109, v219
v_mfma_f32_32x32x16_bf16 v[64:79], a[36:39], v[144:147], v[64:79]
ds_read_b128 a[84:87], v4 offset:41792
ds_read_b128 a[88:91], v4 offset:45408
ds_read_b128 v[156:159], v16 offset:4096
v_dot2_f32_bf16 v216, v110, s88, v216
v_dot2_f32_bf16 v218, v110, v110, v218
v_dot2_f32_bf16 v217, v111, s88, v217
v_dot2_f32_bf16 v219, v111, v111, v219
s_waitcnt lgkmcnt(10)
v_mfma_f32_32x32x16_bf16 v[48:63], a[40:43], v[148:151], v[48:63]
s_add_u32 s28, s57, s25
buffer_load_dwordx4 a[160:163], v11, s[80:83], s28 offen
ds_read_b128 a[92:95], v4 offset:45920
s_waitcnt vmcnt(8)
s_nop 0
ds_write_b128 v33, v[112:115] offset:33536
v_dot2_f32_bf16 v216, v112, s88, v216
v_dot2_f32_bf16 v218, v112, v112, v218
v_dot2_f32_bf16 v217, v113, s88, v217
v_dot2_f32_bf16 v219, v113, v113, v219
v_mfma_f32_32x32x16_bf16 v[64:79], a[44:47], v[148:151], v[64:79]
ds_read_b128 a[96:99], v4 offset:49536
ds_read_b128 a[100:103], v4 offset:50048
ds_read_b128 v[144:147], v13 offset:8192
v_dot2_f32_bf16 v216, v114, s88, v216
v_dot2_f32_bf16 v218, v114, v114, v218
v_dot2_f32_bf16 v217, v115, s88, v217
v_dot2_f32_bf16 v219, v115, v115, v219
s_waitcnt lgkmcnt(10)
v_mfma_f32_32x32x16_bf16 v[48:63], a[48:51], v[152:155], v[48:63]
buffer_load_dwordx4 a[164:167], v37, s[80:83], s28 offen
ds_read_b128 a[104:107], v4 offset:53664
s_waitcnt vmcnt(8)
ds_write_b128 v33, v[120:123] offset:17280
v_dot2_f32_bf16 v220, v120, s88, v220
v_dot2_f32_bf16 v222, v120, v120, v222
v_dot2_f32_bf16 v221, v121, s88, v221
v_dot2_f32_bf16 v223, v121, v121, v223
v_mfma_f32_32x32x16_bf16 v[64:79], a[52:55], v[152:155], v[64:79]
ds_read_b128 a[108:111], v4 offset:54176
ds_read_b128 a[112:115], v4 offset:57792
ds_read_b128 v[148:151], v14 offset:8192
v_dot2_f32_bf16 v220, v122, s88, v220
v_dot2_f32_bf16 v222, v122, v122, v222
v_dot2_f32_bf16 v221, v123, s88, v221
v_dot2_f32_bf16 v223, v123, v123, v223
s_waitcnt lgkmcnt(10)
v_mfma_f32_32x32x16_bf16 v[48:63], a[56:59], v[156:159], v[48:63]
s_add_u32 s28, s57, s25
s_add_u32 s28, s28, 28672
buffer_load_dwordx4 a[168:171], v11, s[80:83], s28 offen
ds_read_b128 a[116:119], v4 offset:58304
s_waitcnt vmcnt(8)
s_nop 0
ds_write_b128 v33, v[124:127] offset:33792
v_dot2_f32_bf16 v220, v124, s88, v220
v_dot2_f32_bf16 v222, v124, v124, v222
v_dot2_f32_bf16 v221, v125, s88, v221
v_dot2_f32_bf16 v223, v125, v125, v223
v_mfma_f32_32x32x16_bf16 v[64:79], a[60:63], v[156:159], v[64:79]
ds_read_b128 a[120:123], v4 offset:61920
ds_read_b128 a[124:127], v4 offset:62432
ds_read_b128 v[152:155], v15 offset:8192
v_dot2_f32_bf16 v220, v126, s88, v220
v_dot2_f32_bf16 v222, v126, v126, v222
v_dot2_f32_bf16 v221, v127, s88, v221
v_dot2_f32_bf16 v223, v127, v127, v223
s_waitcnt lgkmcnt(10)
v_mfma_f32_32x32x16_bf16 v[48:63], a[64:67], v[144:147], v[48:63]
buffer_load_dwordx4 a[172:175], v37, s[80:83], s28 offen
v_add_f32 v208, v208, v209
v_add_f32 v210, v210, v211
v_add_f32 v212, v212, v213
v_add_f32 v214, v214, v215
v_add_f32 v216, v216, v217
v_mfma_f32_32x32x16_bf16 v[64:79], a[68:71], v[144:147], v[64:79]
s_waitcnt lgkmcnt(1)
s_waitcnt vmcnt(6)
s_barrier
ds_read_b128 v[156:159], v16 offset:8192
v_add_f32 v218, v218, v219
v_add_f32 v220, v220, v221
v_add_f32 v222, v222, v223
v_add_f32_dpp v208, v208, v208 quad_perm:[1,0,3,2] row_mask:0xf bank_mask:0xf
v_mfma_f32_32x32x16_bf16 v[48:63], a[72:75], v[148:151], v[48:63]
s_add_u32 m0, s56, 0
s_nop 0
buffer_load_dwordx4 v5, s[52:55], s68 offen offset:0 lds
v_add_f32_dpp v210, v210, v210 quad_perm:[1,0,3,2] row_mask:0xf bank_mask:0xf
v_add_f32_dpp v212, v212, v212 quad_perm:[1,0,3,2] row_mask:0xf bank_mask:0xf
v_add_f32_dpp v214, v214, v214 quad_perm:[1,0,3,2] row_mask:0xf bank_mask:0xf
v_add_f32_dpp v216, v216, v216 quad_perm:[1,0,3,2] row_mask:0xf bank_mask:0xf
v_add_f32_dpp v218, v218, v218 quad_perm:[1,0,3,2] row_mask:0xf bank_mask:0xf
v_mfma_f32_32x32x16_bf16 v[64:79], a[76:79], v[148:151], v[64:79]
ds_read_b128 v[144:147], v13 offset:12288
v_add_f32_dpp v220, v220, v220 quad_perm:[1,0,3,2] row_mask:0xf bank_mask:0xf
v_add_f32_dpp v222, v222, v222 quad_perm:[1,0,3,2] row_mask:0xf bank_mask:0xf
v_add_f32_dpp v208, v208, v208 quad_perm:[2,3,0,1] row_mask:0xf bank_mask:0xf
v_add_f32_dpp v210, v210, v210 quad_perm:[2,3,0,1] row_mask:0xf bank_mask:0xf
s_waitcnt lgkmcnt(2)
s_nop 0
v_mfma_f32_32x32x16_bf16 v[48:63], a[80:83], v[152:155], v[48:63]
buffer_load_dwordx4 v6, s[52:55], s68 offen offset:1024 lds
s_add_u32 s68, s68, 128
v_add_f32_dpp v212, v212, v212 quad_perm:[2,3,0,1] row_mask:0xf bank_mask:0xf
v_add_f32_dpp v214, v214, v214 quad_perm:[2,3,0,1] row_mask:0xf bank_mask:0xf
v_add_f32_dpp v216, v216, v216 quad_perm:[2,3,0,1] row_mask:0xf bank_mask:0xf
v_add_f32_dpp v218, v218, v218 quad_perm:[2,3,0,1] row_mask:0xf bank_mask:0xf
v_add_f32_dpp v220, v220, v220 quad_perm:[2,3,0,1] row_mask:0xf bank_mask:0xf
v_mfma_f32_32x32x16_bf16 v[64:79], a[84:87], v[152:155], v[64:79]
ds_read_b128 v[148:151], v14 offset:12288
v_add_f32_dpp v222, v222, v222 quad_perm:[2,3,0,1] row_mask:0xf bank_mask:0xf
v_add_f32_dpp v208, v208, v208 row_half_mirror row_mask:0xf bank_mask:0xf
v_add_f32_dpp v210, v210, v210 row_half_mirror row_mask:0xf bank_mask:0xf
v_add_f32_dpp v212, v212, v212 row_half_mirror row_mask:0xf bank_mask:0xf
s_waitcnt lgkmcnt(2)
v_mfma_f32_32x32x16_bf16 v[48:63], a[88:91], v[156:159], v[48:63]
s_add_u32 m0, s56, 4096
s_nop 0
buffer_load_dwordx4 v5, s[52:55], s68 offen offset:0 lds
v_add_f32_dpp v214, v214, v214 row_half_mirror row_mask:0xf bank_mask:0xf
v_add_f32_dpp v216, v216, v216 row_half_mirror row_mask:0xf bank_mask:0xf
v_add_f32_dpp v218, v218, v218 row_half_mirror row_mask:0xf bank_mask:0xf
v_add_f32_dpp v220, v220, v220 row_half_mirror row_mask:0xf bank_mask:0xf
v_add_f32_dpp v222, v222, v222 row_half_mirror row_mask:0xf bank_mask:0xf
v_mfma_f32_32x32x16_bf16 v[64:79], a[92:95], v[156:159], v[64:79]
ds_read_b128 v[152:155], v15 offset:12288
v_and_b32 v209, 3, v0
v_lshl_add_u32 v44, v209, 6, v44
v_lshl_add_u32 v45, v209, 5, v45
v_cmp_eq_u32 s[30:31], 1, v209
s_waitcnt lgkmcnt(2)
v_mfma_f32_32x32x16_bf16 v[48:63], a[96:99], v[144:147], v[48:63]
buffer_load_dwordx4 v6, s[52:55], s68 offen offset:1024 lds
s_add_u32 s68, s68, 128
v_cndmask_b32 v208, v208, v212, s[30:31]
v_cndmask_b32 v210, v210, v214, s[30:31]
v_cmp_eq_u32 s[30:31], 2, v209
s_nop 1
v_cndmask_b32 v208, v208, v216, s[30:31]
v_cndmask_b32 v210, v210, v218, s[30:31]
v_mfma_f32_32x32x16_bf16 v[64:79], a[100:103], v[144:147], v[64:79]
ds_read_b128 v[156:159], v16 offset:12288
v_cmp_eq_u32 s[30:31], 3, v209
s_nop 1
v_cndmask_b32 v208, v208, v220, s[30:31]
v_cndmask_b32 v210, v210, v222, s[30:31]
v_mul_f32 v208, 0x3b124925, v208
s_waitcnt lgkmcnt(2)
v_mfma_f32_32x32x16_bf16 v[48:63], a[104:107], v[148:151], v[48:63]
s_add_u32 m0, s24, 0
s_nop 0
buffer_load_dwordx4 v9, s[60:63], s69 offen offset:0 lds
v_mul_f32 v210, 0x3b124925, v210
v_fma_f32 v210, -v208, v208, v210
v_cvt_pk_bf16_f32 v208, v208, v208
v_and_b32 v208, 0xffff0000, v208
v_max_f32 v210, 0, v210
v_mfma_f32_32x32x16_bf16 v[64:79], a[108:111], v[148:151], v[64:79]
s_waitcnt vmcnt(9)
s_barrier
ds_read_b128 v[144:147], v13 offset:16384
ds_read_b128 a[128:131], v3 offset:0
ds_read_b128 a[132:135], v3 offset:512
v_cvt_pk_bf16_f32 v210, v210, v210
v_and_b32 v210, 0xffff0000, v210
v_add_f32 v210, 0x3727c5ac, v210
v_cvt_pk_bf16_f32 v210, v210, v210
s_waitcnt lgkmcnt(4)
global_load_dwordx2 v[224:225], v32, s[44:45] sc1
v_mfma_f32_32x32x16_bf16 v[48:63], a[112:115], v[152:155], v[48:63]
buffer_load_dwordx4 v10, s[60:63], s69 offen offset:1024 lds
s_add_u32 s69, s69, 114688
v_and_b32 v210, 0xffff0000, v210
v_sqrt_f32 v210, v210
ds_write_b32 v44, v208 offset:512
v_cvt_pk_bf16_f32 v210, v210, v210
v_and_b32 v210, 0xffff0000, v210
v_mfma_f32_32x32x16_bf16 v[64:79], a[116:119], v[152:155], v[64:79]
ds_read_b128 v[148:151], v14 offset:16384
ds_read_b128 a[136:139], v3 offset:4128
ds_read_b128 a[140:143], v3 offset:4640
v_rcp_f32 v211, v210
ds_write_b32 v44, v210
ds_write_b32 v45, v211 offset:256
s_waitcnt lgkmcnt(9)
v_mfma_f32_32x32x16_bf16 v[48:63], a[120:123], v[156:159], v[48:63]
s_add_u32 m0, s24, 4096
s_nop 0
buffer_load_dwordx4 v9, s[60:63], s69 offen offset:0 lds
v_mfma_f32_32x32x16_bf16 v[64:79], a[124:127], v[156:159], v[64:79]
ds_read_b128 v[152:155], v15 offset:16384
ds_read_b128 a[144:147], v3 offset:8256
ds_read_b128 a[148:151], v3 offset:8768
s_waitcnt lgkmcnt(9)
v_mfma_f32_32x32x16_bf16 v[48:63], a[128:131], v[144:147], v[48:63]
buffer_load_dwordx4 v10, s[60:63], s69 offen offset:1024 lds
s_add_u32 s69, s69, 114688
v_mfma_f32_32x32x16_bf16 v[64:79], a[132:135], v[144:147], v[64:79]
ds_read_b128 v[156:159], v16 offset:16384
ds_read_b128 a[152:155], v3 offset:12384
ds_read_b128 a[156:159], v3 offset:12896
s_waitcnt lgkmcnt(8)
v_mfma_f32_32x32x16_bf16 v[48:63], a[136:139], v[148:151], v[48:63]
s_add_u32 m0, s24, 8192
s_nop 0
buffer_load_dwordx4 v9, s[60:63], s69 offen offset:0 lds
v_mfma_f32_32x32x16_bf16 v[64:79], a[140:143], v[148:151], v[64:79]
s_waitcnt vmcnt(6)
s_barrier
ds_read_b128 v[144:147], v13 offset:0
ds_read_b128 a[128:131], v3 offset:16512
ds_read_b128 a[132:135], v3 offset:17024
s_waitcnt lgkmcnt(6)
s_nop 0
v_mfma_f32_32x32x16_bf16 v[48:63], a[144:147], v[152:155], v[48:63]
buffer_load_dwordx4 v10, s[60:63], s69 offen offset:1024 lds
s_add_u32 s69, s69, 114688
v_mfma_f32_32x32x16_bf16 v[64:79], a[148:151], v[152:155], v[64:79]
ds_read_b128 v[148:151], v14 offset:0
ds_read_b128 a[136:139], v3 offset:20640
ds_read_b128 a[140:143], v3 offset:21152
s_waitcnt lgkmcnt(6)
v_mfma_f32_32x32x16_bf16 v[48:63], a[152:155], v[156:159], v[48:63]
s_add_u32 m0, s24, 12288
s_nop 0
buffer_load_dwordx4 v9, s[60:63], s69 offen offset:0 lds
v_mfma_f32_32x32x16_bf16 v[64:79], a[156:159], v[156:159], v[64:79]
ds_read_b128 v[152:155], v15 offset:0
ds_read_b128 a[144:147], v3 offset:24768
ds_read_b128 a[148:151], v3 offset:25280
s_waitcnt lgkmcnt(6)
s_nop 0
v_mfma_f32_32x32x16_bf16 v[48:63], a[128:131], v[144:147], v[48:63]
buffer_load_dwordx4 v10, s[60:63], s69 offen offset:1024 lds
s_add_u32 s69, s69, 114688
v_mfma_f32_32x32x16_bf16 v[64:79], a[132:135], v[144:147], v[64:79]
ds_read_b128 v[156:159], v16 offset:0
ds_read_b128 a[152:155], v3 offset:28896
ds_read_b128 a[156:159], v3 offset:29408
s_waitcnt lgkmcnt(6)
v_mfma_f32_32x32x16_bf16 v[48:63], a[136:139], v[148:151], v[48:63]
s_add_u32 m0, s24, 16384
s_nop 0
buffer_load_dwordx4 v9, s[60:63], s69 offen offset:0 lds
v_mfma_f32_32x32x16_bf16 v[64:79], a[140:143], v[148:151], v[64:79]
s_barrier
s_nop 0
ds_read_b128 v[144:147], v13 offset:4096
ds_read_b128 a[128:131], v3 offset:33024
ds_read_b128 a[132:135], v3 offset:33536
ds_read_b32 v30, v46 offset:0
ds_read_b32 v31, v46 offset:128
ds_read_b32 v240, v46 offset:512
ds_read_b32 v244, v46 offset:640
s_waitcnt lgkmcnt(10)
s_nop 0
v_mfma_f32_32x32x16_bf16 v[48:63], a[144:147], v[152:155], v[48:63]
buffer_load_dwordx4 v10, s[60:63], s69 offen offset:1024 lds
s_add_u32 s69, s69, 114688
ds_read_b128 v[176:179], v47 offset:256
ds_read_b128 v[180:183], v47 offset:272
ds_read_b128 v[184:187], v47 offset:288
ds_read_b128 v[188:191], v47 offset:304
ds_read_b128 v[192:195], v47 offset:320
v_mfma_f32_32x32x16_bf16 v[64:79], a[148:151], v[152:155], v[64:79]
ds_read_b128 v[148:151], v14 offset:4096
ds_read_b128 a[136:139], v3 offset:37152
ds_read_b128 a[140:143], v3 offset:37664
ds_read_b128 v[196:199], v47 offset:336
ds_read_b128 v[200:203], v47 offset:352
ds_read_b128 v[204:207], v47 offset:368
s_waitcnt vmcnt(9) lgkmcnt(11)
v_cmp_eq_u32 vcc, v225, v40
s_nop 0
s_cmp_eq_u64 vcc, -1
s_cbranch_scc0 L_rt_cs
L_bk_cs:
v_cmp_eq_u32 s[30:31], 0, v38
v_mfma_f32_32x32x16_bf16 v[48:63], a[152:155], v[156:159], v[48:63]
s_add_u32 m0, s24, 20480
s_nop 0
buffer_load_dwordx4 v9, s[60:63], s69 offen offset:0 lds
v_cvt_pk_bf16_f32 v225, v224, v224
v_lshlrev_b32 v225, 16, v225
v_sub_f32 v225, v224, v225
v_cvt_pk_bf16_f32 v224, v224, v225
v_cndmask_b32 v248, 0, v224, s[30:31]
v_mfma_f32_32x32x16_bf16 v[64:79], a[156:159], v[156:159], v[64:79]
ds_read_b128 v[152:155], v15 offset:4096
ds_read_b128 a[144:147], v3 offset:41280
ds_read_b128 a[148:151], v3 offset:41792
v_cvt_pk_bf16_f32 v240, -v240, -v240
v_cndmask_b32 v240, 0, v240, s[30:31]
v_cvt_pk_bf16_f32 v244, -v244, -v244
v_cndmask_b32 v244, 0, v244, s[30:31]
v_mfma_f32_32x32x16_bf16 v[48:63], a[128:131], v[144:147], v[48:63]
buffer_load_dwordx4 v10, s[60:63], s69 offen offset:1024 lds
s_add_u32 s69, s69, 114688
v_mfma_f32_32x32x16_bf16 v[64:79], a[132:135], v[144:147], v[64:79]
ds_read_b128 v[156:159], v16 offset:4096
ds_read_b128 a[152:155], v3 offset:45408
ds_read_b128 a[156:159], v3 offset:45920
s_waitcnt lgkmcnt(9)
v_mfma_f32_32x32x16_bf16 v[48:63], a[136:139], v[148:151], v[48:63]
s_add_u32 m0, s24, 24576
s_nop 0
buffer_load_dwordx4 v9, s[60:63], s69 offen offset:0 lds
v_mfma_f32_32x32x16_bf16 v[64:79], a[140:143], v[148:151], v[64:79]
s_waitcnt lgkmcnt(3)
v_mfma_f32_32x32x16_bf16 v[48:63], a[144:147], v[152:155], v[48:63]
buffer_load_dwordx4 v10, s[60:63], s69 offen offset:1024 lds
s_add_u32 s69, s69, 114688
v_mfma_f32_32x32x16_bf16 v[64:79], a[148:151], v[152:155], v[64:79]
s_waitcnt lgkmcnt(0)
v_mfma_f32_32x32x16_bf16 v[48:63], a[152:155], v[156:159], v[48:63]
s_add_u32 m0, s24, 28672
s_nop 0
buffer_load_dwordx4 v9, s[60:63], s69 offen offset:0 lds
v_mfma_f32_32x32x16_bf16 v[64:79], a[156:159], v[156:159], v[64:79]
v_mfma_f32_32x32x16_bf16 v[48:63], v[240:243], v[248:251], v[48:63]
v_mfma_f32_32x32x16_bf16 v[64:79], v[244:247], v[248:251], v[64:79]
s_waitcnt vmcnt(7)
s_barrier
s_nop 0
ds_read_b64_tr_b16 v[144:145], v7 offset:0
ds_read_b64_tr_b16 v[146:147], v7 offset:512
ds_read_b64_tr_b16 v[148:149], v8 offset:0
ds_read_b64_tr_b16 v[150:151], v8 offset:512
ds_read_b64_tr_b16 v[152:153], v7 offset:2048
ds_read_b64_tr_b16 v[154:155], v7 offset:2560
ds_read_b64_tr_b16 v[156:157], v8 offset:2048
ds_read_b64_tr_b16 v[158:159], v8 offset:2560
s_nop 0
s_nop 0
v_pk_mul_f32 v[48:49], v[48:49], v[176:177]
v_pk_mul_f32 v[50:51], v[50:51], v[178:179]
v_pk_mul_f32 v[52:53], v[52:53], v[180:181]
v_pk_mul_f32 v[54:55], v[54:55], v[182:183]
v_pk_mul_f32 v[56:57], v[56:57], v[184:185]
v_pk_mul_f32 v[58:59], v[58:59], v[186:187]
v_pk_mul_f32 v[60:61], v[60:61], v[188:189]
v_pk_mul_f32 v[62:63], v[62:63], v[190:191]
v_pk_mul_f32 v[64:65], v[64:65], v[192:193]
v_pk_mul_f32 v[66:67], v[66:67], v[194:195]
v_pk_mul_f32 v[68:69], v[68:69], v[196:197]
v_pk_mul_f32 v[70:71], v[70:71], v[198:199]
v_pk_mul_f32 v[72:73], v[72:73], v[200:201]
v_pk_mul_f32 v[74:75], v[74:75], v[202:203]
v_pk_mul_f32 v[76:77], v[76:77], v[204:205]
v_pk_mul_f32 v[78:79], v[78:79], v[206:207]
s_waitcnt lgkmcnt(4)
v_mfma_f32_32x32x16_bf16 v[80:95], v[144:147], a[0:3], 0
buffer_load_dwordx4 v10, s[60:63], s69 offen offset:1024 lds
s_add_u32 s69, s69, 114688
v_fma_f32 v209, v20, v48, v49
v_fma_f32 v211, v20, v64, v65
s_nop 0
v_fmac_f32_dpp v209, v48, v21 quad_perm:[1,0,3,2] row_mask:0xf bank_mask:0xf
v_fmac_f32_dpp v211, v64, v21 quad_perm:[1,0,3,2] row_mask:0xf bank_mask:0xf
v_fma_f32 v208, v20, v209, v50
v_fma_f32 v210, v20, v211, v66
v_mfma_f32_32x32x16_bf16 v[96:111], v[144:147], a[4:7], 0
ds_read_b64_tr_b16 v[160:161], v7 offset:4096
ds_read_b64_tr_b16 v[162:163], v7 offset:4608
ds_read_b64_tr_b16 v[164:165], v8 offset:4096
ds_read_b64_tr_b16 v[166:167], v8 offset:4608
v_fmac_f32_dpp v208, v209, v21 quad_perm:[1,0,3,2] row_mask:0xf bank_mask:0xf
v_fmac_f32_dpp v210, v211, v21 quad_perm:[1,0,3,2] row_mask:0xf bank_mask:0xf
v_mfma_f32_32x32x16_bf16 v[112:127], v[148:151], a[0:3], 0
s_add_u32 m0, s56, 8192
s_nop 0
buffer_load_dwordx4 v9, s[60:63], s69 offen offset:0 lds
v_fma_f32 v209, v20, v208, v51
v_fma_f32 v211, v20, v210, v67
s_nop 0
v_fmac_f32_dpp v209, v208, v21 quad_perm:[1,0,3,2] row_mask:0xf bank_mask:0xf
v_fmac_f32_dpp v211, v210, v21 quad_perm:[1,0,3,2] row_mask:0xf bank_mask:0xf
v_fma_f32 v208, v20, v209, v52
v_mfma_f32_32x32x16_bf16 v[128:143], v[148:151], a[4:7], 0
v_fma_f32 v210, v20, v211, v68
v_fmac_f32_dpp v208, v209, v21 quad_perm:[1,0,3,2] row_mask:0xf bank_mask:0xf
s_nop 0
v_fmac_f32_dpp v210, v211, v21 quad_perm:[1,0,3,2] row_mask:0xf bank_mask:0xf
v_fma_f32 v209, v20, v208, v53
v_fma_f32 v211, v20, v210, v69
s_nop 0
v_fmac_f32_dpp v209, v208, v21 quad_perm:[1,0,3,2] row_mask:0xf bank_mask:0xf
s_waitcnt lgkmcnt(4)
s_lshl_b32 s92, s7, 9
s_add_u32 s92, s92, 0x1118000
v_lshl_add_u32 v5, v36, 3, s92
global_load_dwordx2 v[236:237], v5, s[44:45] sc1
global_load_dwordx2 v[238:239], v5, s[44:45] offset:256 sc1
v_mfma_f32_32x32x16_bf16 v[80:95], v[152:155], a[8:11], v[80:95]
buffer_load_dwordx4 v10, s[60:63], s69 offen offset:1024 lds
s_add_u32 s69, s69, 114688
v_fmac_f32_dpp v211, v210, v21 quad_perm:[1,0,3,2] row_mask:0xf bank_mask:0xf
v_fma_f32 v208, v20, v209, v54
v_fma_f32 v210, v20, v211, v70
s_nop 0
s_nop 0
v_fmac_f32_dpp v208, v209, v21 quad_perm:[1,0,3,2] row_mask:0xf bank_mask:0xf
v_fmac_f32_dpp v210, v211, v21 quad_perm:[1,0,3,2] row_mask:0xf bank_mask:0xf
v_fma_f32 v209, v20, v208, v55
v_mfma_f32_32x32x16_bf16 v[96:111], v[152:155], a[12:15], v[96:111]
ds_read_b64_tr_b16 v[168:169], v7 offset:6144
ds_read_b64_tr_b16 v[170:171], v7 offset:6656
ds_read_b64_tr_b16 v[172:173], v8 offset:6144
ds_read_b64_tr_b16 v[174:175], v8 offset:6656
v_fma_f32 v211, v20, v210, v71
v_fmac_f32_dpp v209, v208, v21 quad_perm:[1,0,3,2] row_mask:0xf bank_mask:0xf
v_mfma_f32_32x32x16_bf16 v[112:127], v[156:159], a[8:11], v[112:127]
s_add_u32 m0, s56, 12288
s_nop 0
buffer_load_dwordx4 v9, s[60:63], s69 offen offset:0 lds
v_fmac_f32_dpp v211, v210, v21 quad_perm:[1,0,3,2] row_mask:0xf bank_mask:0xf
v_fma_f32 v208, v20, v209, v56
v_fma_f32 v210, v20, v211, v72
s_nop 0
v_fmac_f32_dpp v208, v209, v21 quad_perm:[1,0,3,2] row_mask:0xf bank_mask:0xf
v_fmac_f32_dpp v210, v211, v21 quad_perm:[1,0,3,2] row_mask:0xf bank_mask:0xf
v_mfma_f32_32x32x16_bf16 v[128:143], v[156:159], a[12:15], v[128:143]
v_fma_f32 v209, v20, v208, v57
v_fma_f32 v211, v20, v210, v73
s_nop 0
v_fmac_f32_dpp v209, v208, v21 quad_perm:[1,0,3,2] row_mask:0xf bank_mask:0xf
v_fmac_f32_dpp v211, v210, v21 quad_perm:[1,0,3,2] row_mask:0xf bank_mask:0xf
v_fma_f32 v208, v20, v209, v58
v_fma_f32 v210, v20, v211, v74
s_waitcnt lgkmcnt(4)
v_mfma_f32_32x32x16_bf16 v[80:95], v[160:163], a[16:19], v[80:95]
buffer_load_dwordx4 v10, s[60:63], s69 offen offset:1024 lds
s_add_u32 s69, s69, 114688
v_fmac_f32_dpp v208, v209, v21 quad_perm:[1,0,3,2] row_mask:0xf bank_mask:0xf
v_fmac_f32_dpp v210, v211, v21 quad_perm:[1,0,3,2] row_mask:0xf bank_mask:0xf
v_fma_f32 v209, v20, v208, v59
v_fma_f32 v211, v20, v210, v75
s_nop 0
s_nop 0
v_fmac_f32_dpp v209, v208, v21 quad_perm:[1,0,3,2] row_mask:0xf bank_mask:0xf
v_fmac_f32_dpp v211, v210, v21 quad_perm:[1,0,3,2] row_mask:0xf bank_mask:0xf
v_mfma_f32_32x32x16_bf16 v[96:111], v[160:163], a[20:23], v[96:111]
ds_read_b64_tr_b16 v[144:145], v7 offset:8192
ds_read_b64_tr_b16 v[146:147], v7 offset:8704
ds_read_b64_tr_b16 v[148:149], v8 offset:8192
ds_read_b64_tr_b16 v[150:151], v8 offset:8704
v_fma_f32 v208, v20, v209, v60
v_fma_f32 v210, v20, v211, v76
v_mfma_f32_32x32x16_bf16 v[112:127], v[164:167], a[16:19], v[112:127]
s_add_u32 m0, s56, 16384
s_nop 0
buffer_load_dwordx4 v9, s[60:63], s69 offen offset:0 lds
v_fmac_f32_dpp v208, v209, v21 quad_perm:[1,0,3,2] row_mask:0xf bank_mask:0xf
v_fmac_f32_dpp v210, v211, v21 quad_perm:[1,0,3,2] row_mask:0xf bank_mask:0xf
v_fma_f32 v209, v20, v208, v61
v_fma_f32 v211, v20, v210, v77
s_nop 0
v_fmac_f32_dpp v209, v208, v21 quad_perm:[1,0,3,2] row_mask:0xf bank_mask:0xf
v_mfma_f32_32x32x16_bf16 v[128:143], v[164:167], a[20:23], v[128:143]
v_fmac_f32_dpp v211, v210, v21 quad_perm:[1,0,3,2] row_mask:0xf bank_mask:0xf
v_fma_f32 v208, v20, v209, v62
v_fma_f32 v210, v20, v211, v78
s_nop 0
v_fmac_f32_dpp v208, v209, v21 quad_perm:[1,0,3,2] row_mask:0xf bank_mask:0xf
v_fmac_f32_dpp v210, v211, v21 quad_perm:[1,0,3,2] row_mask:0xf bank_mask:0xf
v_fma_f32 v209, v20, v208, v63
s_waitcnt lgkmcnt(4)
global_load_dword v33, v12, s[44:45] sc1
v_mfma_f32_32x32x16_bf16 v[80:95], v[168:171], a[24:27], v[80:95]
buffer_load_dwordx4 v10, s[60:63], s69 offen offset:1024 lds
s_add_u32 s69, s69, 114688
v_fma_f32 v211, v20, v210, v79
v_fmac_f32_dpp v209, v208, v21 quad_perm:[1,0,3,2] row_mask:0xf bank_mask:0xf
s_nop 0
v_fmac_f32_dpp v211, v210, v21 quad_perm:[1,0,3,2] row_mask:0xf bank_mask:0xf
v_mov_b32 v34, v209
v_lshlrev_b32 v46, 3, v36
v_mov_b32 v45, v40
v_mfma_f32_32x32x16_bf16 v[96:111], v[168:171], a[28:31], v[96:111]
ds_read_b64_tr_b16 v[152:153], v7 offset:10240
ds_read_b64_tr_b16 v[154:155], v7 offset:10752
ds_read_b64_tr_b16 v[156:157], v8 offset:10240
ds_read_b64_tr_b16 v[158:159], v8 offset:10752
v_fma_f32 v35, v22, v34, v211
s_nop 1
v_fmac_f32_dpp v35, v34, v23 quad_perm:[1,0,3,2] row_mask:0xf bank_mask:0xf
v_mfma_f32_32x32x16_bf16 v[112:127], v[172:175], a[24:27], v[112:127]
s_add_u32 m0, s56, 0
s_nop 0
buffer_load_dwordx4 v9, s[60:63], s69 offen offset:0 lds
v_mov_b32 v39, v35
s_lshl_b32 s13, s93, 8
s_nop 0
v_permlane32_swap_b32 v35, v39
v_fma_f32 v44, v24, v35, v39
s_nop 1
v_fmac_f32_dpp v44, v35, v25 quad_perm:[1,0,3,2] row_mask:0xf bank_mask:0xf
v_mfma_f32_32x32x16_bf16 v[128:143], v[172:175], a[28:31], v[128:143]
buffer_store_dwordx2 v[44:45], v46, s[72:75], s13 offen sc1
v_and_b32 v47, 1, v0
v_lshl_add_u32 v47, v38, 1, v47
v_lshlrev_b32 v47, 8, v47
v_and_b32 v46, 30, v0
v_lshlrev_b32 v46, 3, v46
s_waitcnt lgkmcnt(4)
v_mfma_f32_32x32x16_bf16 v[80:95], v[144:147], a[32:35], v[80:95]
buffer_load_dwordx4 v10, s[60:63], s69 offen offset:1024 lds
s_add_u32 s69, s69, 114688
v_sub_u32 v47, v46, v47
s_sub_u32 s13, s13, 256
v_add_u32_e64 v208, s13, v47
v_subrev_u32 v209, 1024, v208
v_subrev_u32 v210, 2048, v208
v_subrev_u32 v211, 3072, v208
v_mfma_f32_32x32x16_bf16 v[96:111], v[144:147], a[36:39], v[96:111]
ds_read_b64_tr_b16 v[160:161], v7 offset:12288
ds_read_b64_tr_b16 v[162:163], v7 offset:12800
ds_read_b64_tr_b16 v[164:165], v8 offset:12288
ds_read_b64_tr_b16 v[166:167], v8 offset:12800
v_subrev_u32 v212, 4096, v208
v_subrev_u32 v213, 5120, v208
v_mfma_f32_32x32x16_bf16 v[112:127], v[148:151], a[32:35], v[112:127]
s_add_u32 m0, s56, 4096
s_nop 0
buffer_load_dwordx4 v9, s[60:63], s69 offen offset:0 lds
v_subrev_u32 v214, 6144, v208
v_subrev_u32 v215, 7168, v208
s_mov_b32 s64, s44
s_mov_b32 s65, s45
s_mov_b32 s66, 0xa80000
v_mfma_f32_32x32x16_bf16 v[128:143], v[148:151], a[36:39], v[128:143]
s_mov_b32 s67, 0x00020000
s_mul_i32 s58, s4, 4608
s_add_u32 s58, s58, 53248
s_mul_i32 s3, s93, 28
s_add_u32 s3, s3, s7
s_mul_i32 s46, s3, 12288
s_waitcnt lgkmcnt(4)
v_mfma_f32_32x32x16_bf16 v[80:95], v[152:155], a[40:43], v[80:95]
buffer_load_dwordx4 v10, s[60:63], s69 offen offset:1024 lds
s_add_u32 s69, s69, 114688
s_add_u32 s47, s46, 4096
s_add_u32 s15, s46, 8192
s_lshl_b32 s3, s5, 1
s_add_u32 s11, s3, s8
s_mul_i32 s3, s11, 28
v_mfma_f32_32x32x16_bf16 v[96:111], v[152:155], a[44:47], v[96:111]
ds_read_b64_tr_b16 v[168:169], v7 offset:14336
ds_read_b64_tr_b16 v[170:171], v7 offset:14848
ds_read_b64_tr_b16 v[172:173], v8 offset:14336
ds_read_b64_tr_b16 v[174:175], v8 offset:14848
s_add_u32 s3, s3, s87
v_mfma_f32_32x32x16_bf16 v[112:127], v[156:159], a[40:43], v[112:127]
s_cmp_ge_u32 s7, 2
s_cselect_b32 s57, 0, 114688
s_add_u32 s28, s57, s25
buffer_load_dwordx4 a[176:179], v11, s[80:83], s28 offen
s_mul_i32 s91, s3, 12288
s_lshl_b32 s3, s86, 11
s_add_u32 s91, s91, s3
s_lshr_b32 s3, s7, 1
v_mfma_f32_32x32x16_bf16 v[128:143], v[156:159], a[44:47], v[128:143]
s_mul_i32 s23, s3, 24576
s_lshl_b32 s11, s11, 1
s_add_u32 s11, s11, s87
s_lshl_b32 s11, s11, 12
s_add_u32 s11, s11, 0x1040000
s_waitcnt lgkmcnt(4)
v_mfma_f32_32x32x16_bf16 v[80:95], v[160:163], a[48:51], v[80:95]
buffer_load_dwordx4 a[180:183], v37, s[80:83], s28 offen
v_min_u32 v16, 13, v0
v_lshl_add_u32 v16, v16, 8, s11
s_lshl_b32 s11, s93, 1
s_add_u32 s11, s11, s87
s_lshl_b32 s11, s11, 12
v_mfma_f32_32x32x16_bf16 v[96:111], v[160:163], a[52:55], v[96:111]
s_waitcnt vmcnt(15)
s_barrier
ds_read_b64_tr_b16 v[144:145], v7 offset:16384
ds_read_b64_tr_b16 v[146:147], v7 offset:16896
ds_read_b64_tr_b16 v[148:149], v8 offset:16384
ds_read_b64_tr_b16 v[150:151], v8 offset:16896
s_lshl_b32 s3, s3, 8
v_mfma_f32_32x32x16_bf16 v[112:127], v[164:167], a[48:51], v[112:127]
s_add_u32 m0, s24, 0
s_nop 0
buffer_load_dwordx4 v9, s[60:63], s69 offen offset:0 lds
s_add_u32 s3, s3, s11
s_add_u32 s3, s3, 0x1040000
v_mov_b32_e64 v14, s3
v_subrev_u32 v13, 0x40000, v14
v_mfma_f32_32x32x16_bf16 v[128:143], v[164:167], a[52:55], v[128:143]
v_subrev_u32 v15, 0x40000, v16
s_waitcnt lgkmcnt(4)
v_mfma_f32_32x32x16_bf16 v[80:95], v[168:171], a[56:59], v[80:95]
buffer_load_dwordx4 v10, s[60:63], s69 offen offset:1024 lds
s_add_u32 s69, s69, 114688
v_mfma_f32_32x32x16_bf16 v[96:111], v[168:171], a[60:63], v[96:111]
ds_read_b64_tr_b16 v[152:153], v7 offset:18432
ds_read_b64_tr_b16 v[154:155], v7 offset:18944
ds_read_b64_tr_b16 v[156:157], v8 offset:18432
ds_read_b64_tr_b16 v[158:159], v8 offset:18944
v_mfma_f32_32x32x16_bf16 v[112:127], v[172:175], a[56:59], v[112:127]
s_add_u32 s28, s57, s25
s_add_u32 s28, s28, 28672
buffer_load_dwordx4 a[184:187], v11, s[80:83], s28 offen
v_mfma_f32_32x32x16_bf16 v[128:143], v[172:175], a[60:63], v[128:143]
s_waitcnt lgkmcnt(4)
v_mfma_f32_32x32x16_bf16 v[80:95], v[144:147], a[64:67], v[80:95]
buffer_load_dwordx4 a[188:191], v37, s[80:83], s28 offen
s_waitcnt vmcnt(16)
v_xor_b32 v1, v237, v40
v_xor_b32 v41, v239, v40
v_or_b32 v1, v1, v41
v_cmp_eq_u32 vcc, 0, v1
s_nop 0
s_cmp_eq_u64 vcc, -1
s_cbranch_scc0 L_rt_cw
L_bk_cw:
v_cvt_pk_bf16_f32 v237, v236, v236
v_lshlrev_b32 v237, 16, v237
v_sub_f32 v237, v236, v237
v_cvt_pk_bf16_f32 v236, v236, v237
v_mfma_f32_32x32x16_bf16 v[96:111], v[144:147], a[68:71], v[96:111]
ds_read_b64_tr_b16 v[160:161], v7 offset:20480
ds_read_b64_tr_b16 v[162:163], v7 offset:20992
ds_read_b64_tr_b16 v[164:165], v8 offset:20480
ds_read_b64_tr_b16 v[166:167], v8 offset:20992
v_cndmask_b32 v252, 0, v236, s[30:31]
v_mfma_f32_32x32x16_bf16 v[112:127], v[148:151], a[64:67], v[112:127]
s_cmp_ge_u32 s7, 4
s_cselect_b32 s57, 0, 114688
s_add_u32 s57, s57, 114688
s_add_u32 s28, s57, s25
buffer_load_dwordx4 a[192:195], v11, s[80:83], s28 offen
v_cvt_pk_bf16_f32 v239, v238, v238
v_lshlrev_b32 v239, 16, v239
v_sub_f32 v239, v238, v239
v_cvt_pk_bf16_f32 v238, v238, v239
v_mfma_f32_32x32x16_bf16 v[128:143], v[148:151], a[68:71], v[128:143]
v_cndmask_b32 v248, 0, v238, s[30:31]
v_mfma_f32_32x32x16_bf16 v[80:95], v[252:255], v[240:243], v[80:95]
v_mfma_f32_32x32x16_bf16 v[96:111], v[252:255], v[244:247], v[96:111]
v_mfma_f32_32x32x16_bf16 v[112:127], v[248:251], v[240:243], v[112:127]
v_mfma_f32_32x32x16_bf16 v[128:143], v[248:251], v[244:247], v[128:143]
v_lshrrev_b32 v5, 4, v0
v_and_b32 v6, 15, v0
s_lshl_b32 s3, s86, 4
s_waitcnt lgkmcnt(4)
v_mfma_f32_32x32x16_bf16 v[80:95], v[152:155], a[72:75], v[80:95]
buffer_load_dwordx4 a[196:199], v37, s[80:83], s28 offen
s_lshl_b32 s11, s87, 3
s_add_u32 s3, s3, s11
v_add_u32 v234, s3, v5
s_lshl_b32 s11, s5, 1
s_add_u32 s11, s11, s8
v_mfma_f32_32x32x16_bf16 v[96:111], v[152:155], a[76:79], v[96:111]
ds_read_b64_tr_b16 v[168:169], v7 offset:22528
ds_read_b64_tr_b16 v[170:171], v7 offset:23040
ds_read_b64_tr_b16 v[172:173], v8 offset:22528
ds_read_b64_tr_b16 v[174:175], v8 offset:23040
s_lshl_b32 s11, s11, 6
v_mfma_f32_32x32x16_bf16 v[112:127], v[156:159], a[72:75], v[112:127]
s_add_u32 s28, s57, s25
s_add_u32 s28, s28, 28672
buffer_load_dwordx4 a[200:203], v11, s[80:83], s28 offen
v_add_u32 v9, s11, v234
s_mul_i32 s3, s8, 768
s_add_u32 s3, s3, 115584
v_lshl_add_u32 v234, v234, 2, s3
v_mfma_f32_32x32x16_bf16 v[128:143], v[156:159], a[76:79], v[128:143]
s_lshl_b32 s11, s4, 6
s_add_u32 s3, s3, s11
v_lshl_add_u32 v235, v5, 2, s3
s_lshl_b32 s11, s6, 7
v_lshl_add_u32 v236, v6, 3, s11
s_waitcnt lgkmcnt(4)
s_waitcnt vmcnt(14)
v_cmp_eq_u32 vcc, v33, v40
s_nop 0
s_cmp_eq_u64 vcc, -1
s_cbranch_scc0 L_rt_bt
L_bk_bt:
v_mfma_f32_32x32x16_bf16 v[80:95], v[160:163], a[80:83], v[80:95]
buffer_load_dwordx4 a[204:207], v37, s[80:83], s28 offen
v_mul_u32_u24 v9, 896, v9
v_add_u32 v9, v9, v236
s_mov_b32 s20, 28672
s_mov_b32 s21, 3584
s_mov_b32 s22, 32256
v_mfma_f32_32x32x16_bf16 v[96:111], v[160:163], a[84:87], v[96:111]
ds_read_b64_tr_b16 v[144:145], v7 offset:24576
ds_read_b64_tr_b16 v[146:147], v7 offset:25088
ds_read_b64_tr_b16 v[148:149], v8 offset:24576
ds_read_b64_tr_b16 v[150:151], v8 offset:25088
buffer_load_dwordx2 v[216:217], v9, s[48:51], 0 offen
v_mfma_f32_32x32x16_bf16 v[112:127], v[164:167], a[80:83], v[112:127]
s_cmp_ge_u32 s7, 6
s_cselect_b32 s57, 0, 114688
s_add_u32 s57, s57, 229376
s_add_u32 s28, s57, s25
buffer_load_dwordx4 a[208:211], v11, s[80:83], s28 offen
buffer_load_dwordx2 v[218:219], v9, s[48:51], s20 offen
v_mfma_f32_32x32x16_bf16 v[128:143], v[164:167], a[84:87], v[128:143]
buffer_load_dwordx2 v[220:221], v9, s[48:51], s21 offen
s_waitcnt lgkmcnt(4)
s_nop 0
v_mfma_f32_32x32x16_bf16 v[80:95], v[168:171], a[88:91], v[80:95]
buffer_load_dwordx4 a[212:215], v37, s[80:83], s28 offen
buffer_load_dwordx2 v[222:223], v9, s[48:51], s22 offen
v_mfma_f32_32x32x16_bf16 v[96:111], v[168:171], a[92:95], v[96:111]
ds_read_b64_tr_b16 v[152:153], v7 offset:26624
ds_read_b64_tr_b16 v[154:155], v7 offset:27136
ds_read_b64_tr_b16 v[156:157], v8 offset:26624
ds_read_b64_tr_b16 v[158:159], v8 offset:27136
v_mfma_f32_32x32x16_bf16 v[112:127], v[172:175], a[88:91], v[112:127]
s_add_u32 s28, s57, s25
s_nop 0
s_add_u32 s28, s28, 28672
buffer_load_dwordx4 a[216:219], v11, s[80:83], s28 offen
global_load_dwordx2 v[224:225], v236, s[32:33]
ds_read_b32 v226, v235 offset:512
ds_read_b32 v227, v234 offset:256
ds_read_b32 v228, v235 offset:528
v_mfma_f32_32x32x16_bf16 v[128:143], v[172:175], a[92:95], v[128:143]
ds_read_b32 v229, v234 offset:384
ds_read_b32 v230, v235 offset:544
ds_read_b32 v231, v234 offset:272
ds_read_b32 v232, v235 offset:560
ds_read_b32 v233, v234 offset:400
s_waitcnt lgkmcnt(12)
v_mfma_f32_32x32x16_bf16 v[80:95], v[144:147], a[96:99], v[80:95]
buffer_load_dwordx4 a[220:223], v37, s[80:83], s28 offen
v_lshlrev_b32 v9, 1, v9
v_mfma_f32_32x32x16_bf16 v[96:111], v[144:147], a[100:103], v[96:111]
ds_read_b64_tr_b16 v[160:161], v7 offset:28672
ds_read_b64_tr_b16 v[162:163], v7 offset:29184
ds_read_b64_tr_b16 v[164:165], v8 offset:28672
ds_read_b64_tr_b16 v[166:167], v8 offset:29184
v_mfma_f32_32x32x16_bf16 v[112:127], v[148:151], a[96:99], v[112:127]
s_cmp_ge_u32 s7, 8
s_cselect_b32 s57, 0, 114688
s_add_u32 s57, s57, 344064
s_add_u32 s28, s57, s25
buffer_load_dwordx4 a[224:227], v11, s[80:83], s28 offen
v_mfma_f32_32x32x16_bf16 v[128:143], v[148:151], a[100:103], v[128:143]
s_waitcnt lgkmcnt(12)
s_nop 0
v_mfma_f32_32x32x16_bf16 v[80:95], v[152:155], a[104:107], v[80:95]
buffer_load_dwordx4 a[228:231], v37, s[80:83], s28 offen
v_mfma_f32_32x32x16_bf16 v[96:111], v[152:155], a[108:111], v[96:111]
ds_read_b64_tr_b16 v[168:169], v7 offset:30720
ds_read_b64_tr_b16 v[170:171], v7 offset:31232
ds_read_b64_tr_b16 v[172:173], v8 offset:30720
ds_read_b64_tr_b16 v[174:175], v8 offset:31232
v_mfma_f32_32x32x16_bf16 v[112:127], v[156:159], a[104:107], v[112:127]
s_add_u32 s28, s57, s25
s_add_u32 s28, s28, 28672
buffer_load_dwordx4 a[232:235], v11, s[80:83], s28 offen
v_mfma_f32_32x32x16_bf16 v[128:143], v[156:159], a[108:111], v[128:143]
s_waitcnt lgkmcnt(4)
v_mfma_f32_32x32x16_bf16 v[80:95], v[160:163], a[112:115], v[80:95]
buffer_load_dwordx4 a[236:239], v37, s[80:83], s28 offen
v_mfma_f32_32x32x16_bf16 v[96:111], v[160:163], a[116:119], v[96:111]
s_waitcnt vmcnt(25)
s_barrier
ds_read_b64_tr_b16 v[144:145], v17 offset:8192
ds_read_b64_tr_b16 v[146:147], v17 offset:8704
ds_read_b64_tr_b16 v[148:149], v18 offset:8192
ds_read_b64_tr_b16 v[150:151], v18 offset:8704
ds_read_b128 a[128:131], v3 offset:0
ds_read_b128 a[132:135], v3 offset:512
v_mfma_f32_32x32x16_bf16 v[112:127], v[164:167], a[112:115], v[112:127]
s_cmp_ge_u32 s7, 10
s_cselect_b32 s57, 0, 114688
s_add_u32 s57, s57, 458752
s_add_u32 s28, s57, s25
buffer_load_dwordx4 a[240:243], v11, s[80:83], s28 offen
v_mfma_f32_32x32x16_bf16 v[128:143], v[164:167], a[116:119], v[128:143]
s_waitcnt lgkmcnt(6)
s_nop 0
v_mfma_f32_32x32x16_bf16 v[80:95], v[168:171], a[120:123], v[80:95]
buffer_load_dwordx4 a[244:247], v37, s[80:83], s28 offen
v_mfma_f32_32x32x16_bf16 v[96:111], v[168:171], a[124:127], v[96:111]
ds_read_b64_tr_b16 v[152:153], v17 offset:10240
ds_read_b64_tr_b16 v[154:155], v17 offset:10752
ds_read_b64_tr_b16 v[156:157], v18 offset:10240
ds_read_b64_tr_b16 v[158:159], v18 offset:10752
ds_read_b128 a[136:139], v3 offset:4128
ds_read_b128 a[140:143], v3 offset:4640
v_mfma_f32_32x32x16_bf16 v[112:127], v[172:175], a[120:123], v[112:127]
s_add_u32 s28, s57, s25
s_add_u32 s28, s28, 28672
buffer_load_dwordx4 a[248:251], v11, s[80:83], s28 offen
v_mfma_f32_32x32x16_bf16 v[128:143], v[172:175], a[124:127], v[128:143]
s_waitcnt lgkmcnt(6)
v_mfma_f32_32x32x16_bf16 v[80:95], v[144:147], a[128:131], v[80:95]
buffer_load_dwordx4 a[252:255], v37, s[80:83], s28 offen
v_mfma_f32_32x32x16_bf16 v[96:111], v[144:147], a[132:135], v[96:111]
ds_read_b64_tr_b16 v[160:161], v17 offset:12288
ds_read_b64_tr_b16 v[162:163], v17 offset:12800
ds_read_b64_tr_b16 v[164:165], v18 offset:12288
ds_read_b64_tr_b16 v[166:167], v18 offset:12800
ds_read_b128 a[144:147], v3 offset:8256
ds_read_b128 a[148:151], v3 offset:8768
v_mfma_f32_32x32x16_bf16 v[112:127], v[148:151], a[128:131], v[112:127]
s_cmp_ge_u32 s7, 12
s_cselect_b32 s57, 0, 114688
s_add_u32 s57, s57, 573440
s_add_u32 s28, s57, s25
buffer_load_dwordx4 a[0:3], v11, s[80:83], s28 offen
v_mfma_f32_32x32x16_bf16 v[128:143], v[148:151], a[132:135], v[128:143]
s_waitcnt lgkmcnt(6)
v_mfma_f32_32x32x16_bf16 v[80:95], v[152:155], a[136:139], v[80:95]
buffer_load_dwordx4 a[4:7], v37, s[80:83], s28 offen
s_waitcnt vmcnt(11)
v_lshlrev_b32 v234, 16, v224
v_and_b32 v235, 0xffff0000, v224
v_lshlrev_b32 v236, 16, v225
v_and_b32 v237, 0xffff0000, v225
v_mfma_f32_32x32x16_bf16 v[96:111], v[152:155], a[140:143], v[96:111]
ds_read_b64_tr_b16 v[168:169], v17 offset:14336
ds_read_b64_tr_b16 v[170:171], v17 offset:14848
ds_read_b64_tr_b16 v[172:173], v18 offset:14336
ds_read_b64_tr_b16 v[174:175], v18 offset:14848
ds_read_b128 a[152:155], v3 offset:12384
ds_read_b128 a[156:159], v3 offset:12896
v_lshlrev_b32 v240, 16, v216
v_mfma_f32_32x32x16_bf16 v[112:127], v[156:159], a[136:139], v[112:127]
s_add_u32 s28, s57, s25
s_add_u32 s28, s28, 28672
buffer_load_dwordx4 a[8:11], v11, s[80:83], s28 offen
v_and_b32 v241, 0xffff0000, v216
v_sub_f32 v238, v240, v226
v_sub_f32 v239, v241, v226
v_cvt_pk_bf16_f32 v1, v238, v239
v_mfma_f32_32x32x16_bf16 v[128:143], v[156:159], a[140:143], v[128:143]
v_lshlrev_b32 v238, 16, v1
v_and_b32 v239, 0xffff0000, v1
v_mul_f32 v238, v238, v227
v_mul_f32 v239, v239, v227
v_cvt_pk_bf16_f32 v1, v238, v239
s_waitcnt lgkmcnt(6)
v_mfma_f32_32x32x16_bf16 v[80:95], v[160:163], a[144:147], v[80:95]
buffer_load_dwordx4 a[12:15], v37, s[80:83], s28 offen
v_lshlrev_b32 v238, 16, v1
v_and_b32 v239, 0xffff0000, v1
v_mul_f32 v238, v238, v234
v_mul_f32_e64 v239, v239, v235
v_cvt_pk_bf16_f32 v1, v238, v239
v_mfma_f32_32x32x16_bf16 v[96:111], v[160:163], a[148:151], v[96:111]
ds_read_b64_tr_b16 v[144:145], v17 offset:16384
ds_read_b64_tr_b16 v[146:147], v17 offset:16896
ds_read_b64_tr_b16 v[148:149], v18 offset:16384
ds_read_b64_tr_b16 v[150:151], v18 offset:16896
ds_read_b128 a[128:131], v3 offset:16512
ds_read_b128 a[132:135], v3 offset:17024
v_lshlrev_b32 v238, 16, v1
v_mfma_f32_32x32x16_bf16 v[112:127], v[164:167], a[144:147], v[112:127]
s_cmp_ge_u32 s7, 14
s_cselect_b32 s57, 0, 114688
s_add_u32 s57, s57, 688128
s_add_u32 s28, s57, s25
buffer_load_dwordx4 a[16:19], v11, s[80:83], s28 offen
v_and_b32 v239, 0xffff0000, v1
v_add_f32 v240, v240, v238
v_add_f32 v241, v241, v239
v_lshlrev_b32 v242, 16, v217
v_mfma_f32_32x32x16_bf16 v[128:143], v[164:167], a[148:151], v[128:143]
v_and_b32 v243, 0xffff0000, v217
v_sub_f32 v238, v242, v226
v_sub_f32 v239, v243, v226
v_cvt_pk_bf16_f32 v1, v238, v239
v_lshlrev_b32 v238, 16, v1
s_waitcnt lgkmcnt(6)
v_mfma_f32_32x32x16_bf16 v[80:95], v[168:171], a[152:155], v[80:95]
buffer_load_dwordx4 a[20:23], v37, s[80:83], s28 offen
v_and_b32 v239, 0xffff0000, v1
v_mul_f32 v238, v238, v227
v_mul_f32 v239, v239, v227
v_cvt_pk_bf16_f32 v1, v238, v239
v_lshlrev_b32_e64 v238, 16, v1
v_mfma_f32_32x32x16_bf16 v[96:111], v[168:171], a[156:159], v[96:111]
ds_read_b64_tr_b16 v[152:153], v17 offset:18432
ds_read_b64_tr_b16 v[154:155], v17 offset:18944
ds_read_b64_tr_b16 v[156:157], v18 offset:18432
ds_read_b64_tr_b16 v[158:159], v18 offset:18944
ds_read_b128 a[136:139], v3 offset:20640
ds_read_b128 a[140:143], v3 offset:21152
v_and_b32 v239, 0xffff0000, v1
v_mfma_f32_32x32x16_bf16 v[112:127], v[172:175], a[152:155], v[112:127]
s_add_u32 s28, s57, s25
s_add_u32 s28, s28, 28672
buffer_load_dwordx4 a[24:27], v11, s[80:83], s28 offen
v_mul_f32 v238, v238, v236
v_mul_f32 v239, v239, v237
v_cvt_pk_bf16_f32 v1, v238, v239
v_lshlrev_b32 v238, 16, v1
v_mfma_f32_32x32x16_bf16 v[128:143], v[172:175], a[156:159], v[128:143]
v_and_b32 v239, 0xffff0000, v1
v_add_f32 v242, v242, v238
v_add_f32 v243, v243, v239
v_lshlrev_b32 v244, 16, v218
v_and_b32 v245, 0xffff0000, v218
s_waitcnt lgkmcnt(6)
v_mfma_f32_32x32x16_bf16 v[80:95], v[144:147], a[128:131], v[80:95]
buffer_load_dwordx4 a[28:31], v37, s[80:83], s28 offen
v_sub_f32 v238, v244, v228
v_sub_f32 v239, v245, v228
v_cvt_pk_bf16_f32 v1, v238, v239
v_lshlrev_b32_e64 v238, 16, v1
v_and_b32 v239, 0xffff0000, v1
v_mfma_f32_32x32x16_bf16 v[96:111], v[144:147], a[132:135], v[96:111]
ds_read_b64_tr_b16 v[160:161], v17 offset:0
ds_read_b64_tr_b16 v[162:163], v17 offset:512
ds_read_b64_tr_b16 v[164:165], v18 offset:0
ds_read_b64_tr_b16 v[166:167], v18 offset:512
ds_read_b128 a[144:147], v3 offset:24768
ds_read_b128 a[148:151], v3 offset:25280
v_mul_f32 v238, v238, v229
v_mfma_f32_32x32x16_bf16 v[112:127], v[148:151], a[128:131], v[112:127]
s_cmp_ge_u32 s7, 16
s_cselect_b32 s57, 0, 114688
s_add_u32 s57, s57, 802816
s_add_u32 s28, s57, s25
buffer_load_dwordx4 a[32:35], v11, s[80:83], s28 offen
v_mul_f32 v239, v239, v229
v_cvt_pk_bf16_f32 v1, v238, v239
v_lshlrev_b32 v238, 16, v1
v_and_b32 v239, 0xffff0000, v1
v_mfma_f32_32x32x16_bf16 v[128:143], v[148:151], a[132:135], v[128:143]
v_mul_f32 v238, v238, v234
v_mul_f32 v239, v239, v235
v_cvt_pk_bf16_f32 v1, v238, v239
v_lshlrev_b32 v238, 16, v1
v_and_b32 v239, 0xffff0000, v1
s_waitcnt lgkmcnt(6)
v_mfma_f32_32x32x16_bf16 v[80:95], v[152:155], a[136:139], v[80:95]
buffer_load_dwordx4 a[36:39], v37, s[80:83], s28 offen
v_add_f32 v244, v244, v238
v_add_f32 v245, v245, v239
v_lshlrev_b32 v246, 16, v219
v_and_b32 v247, 0xffff0000, v219
v_sub_f32_e64 v238, v246, v228
v_mfma_f32_32x32x16_bf16 v[96:111], v[152:155], a[140:143], v[96:111]
ds_read_b64_tr_b16 v[168:169], v17 offset:2048
ds_read_b64_tr_b16 v[170:171], v17 offset:2560
ds_read_b64_tr_b16 v[172:173], v18 offset:2048
ds_read_b64_tr_b16 v[174:175], v18 offset:2560
ds_read_b128 a[152:155], v3 offset:28896
ds_read_b128 a[156:159], v3 offset:29408
v_sub_f32 v239, v247, v228
v_mfma_f32_32x32x16_bf16 v[112:127], v[156:159], a[136:139], v[112:127]
s_add_u32 s28, s57, s25
s_add_u32 s28, s28, 28672
buffer_load_dwordx4 a[40:43], v11, s[80:83], s28 offen
v_cvt_pk_bf16_f32 v1, v238, v239
v_lshlrev_b32 v238, 16, v1
v_and_b32 v239, 0xffff0000, v1
v_mul_f32 v238, v238, v229
v_mfma_f32_32x32x16_bf16 v[128:143], v[156:159], a[140:143], v[128:143]
v_mul_f32 v239, v239, v229
v_cvt_pk_bf16_f32 v1, v238, v239
v_lshlrev_b32 v238, 16, v1
v_and_b32 v239, 0xffff0000, v1
v_mul_f32 v238, v238, v236
s_waitcnt lgkmcnt(6)
v_mfma_f32_32x32x16_bf16 v[80:95], v[160:163], a[144:147], v[80:95]
buffer_load_dwordx4 a[44:47], v37, s[80:83], s28 offen
v_mul_f32 v239, v239, v237
v_cvt_pk_bf16_f32 v1, v238, v239
v_lshlrev_b32 v238, 16, v1
v_and_b32 v239, 0xffff0000, v1
v_add_f32 v246, v246, v238
v_mfma_f32_32x32x16_bf16 v[96:111], v[160:163], a[148:151], v[96:111]
s_barrier
ds_read_b64_tr_b16 v[144:145], v17 offset:4096
ds_read_b64_tr_b16 v[146:147], v17 offset:4608
ds_read_b64_tr_b16 v[148:149], v18 offset:4096
ds_read_b64_tr_b16 v[150:151], v18 offset:4608
ds_read_b128 a[128:131], v3 offset:33024
ds_read_b128 a[132:135], v3 offset:33536
v_add_f32 v247, v247, v239
v_mfma_f32_32x32x16_bf16 v[112:127], v[164:167], a[144:147], v[112:127]
s_add_u32 s92, s84, s27
buffer_load_dwordx4 a[48:51], v19, s[76:79], s92 offen offset:0 sc1
v_lshlrev_b32 v248, 16, v220
v_and_b32 v249, 0xffff0000, v220
v_sub_f32 v238, v248, v230
v_sub_f32 v239, v249, v230
v_mfma_f32_32x32x16_bf16 v[128:143], v[164:167], a[148:151], v[128:143]
v_cvt_pk_bf16_f32 v1, v238, v239
v_lshlrev_b32 v238, 16, v1
v_and_b32 v239, 0xffff0000, v1
v_mul_f32 v238, v238, v231
v_mul_f32 v239, v239, v231
s_waitcnt lgkmcnt(6)
v_mfma_f32_32x32x16_bf16 v[80:95], v[168:171], a[152:155], v[80:95]
buffer_load_dwordx4 a[52:55], v19, s[76:79], s92 offen offset:1024 sc1
v_cvt_pk_bf16_f32 v1, v238, v239
v_lshlrev_b32 v238, 16, v1
v_and_b32 v239, 0xffff0000, v1
v_mul_f32 v238, v238, v234
v_mul_f32 v239, v239, v235
v_mfma_f32_32x32x16_bf16 v[96:111], v[168:171], a[156:159], v[96:111]
ds_read_b64_tr_b16 v[152:153], v17 offset:6144
ds_read_b64_tr_b16 v[154:155], v17 offset:6656
ds_read_b64_tr_b16 v[156:157], v18 offset:6144
ds_read_b64_tr_b16 v[158:159], v18 offset:6656
ds_read_b128 a[136:139], v3 offset:37152
ds_read_b128 a[140:143], v3 offset:37664
v_cvt_pk_bf16_f32 v1, v238, v239
v_mfma_f32_32x32x16_bf16 v[112:127], v[172:175], a[152:155], v[112:127]
s_cmp_ge_u32 s7, 2
s_cselect_b32 s27, 0, 2048
s_add_u32 s92, s84, s27
buffer_load_dwordx4 a[56:59], v19, s[76:79], s92 offen offset:0 sc1
v_lshlrev_b32 v238, 16, v1
v_and_b32 v239, 0xffff0000, v1
v_add_f32 v248, v248, v238
v_add_f32 v249, v249, v239
v_mfma_f32_32x32x16_bf16 v[128:143], v[172:175], a[156:159], v[128:143]
v_lshlrev_b32 v250, 16, v221
v_and_b32 v251, 0xffff0000, v221
v_sub_f32 v238, v250, v230
v_sub_f32 v239, v251, v230
v_cvt_pk_bf16_f32 v1, v238, v239
s_waitcnt lgkmcnt(6)
v_mfma_f32_32x32x16_bf16 v[80:95], v[144:147], a[128:131], v[80:95]
buffer_load_dwordx4 a[60:63], v19, s[76:79], s92 offen offset:1024 sc1
v_lshlrev_b32 v238, 16, v1
v_and_b32 v239, 0xffff0000, v1
v_mul_f32 v238, v238, v231
v_mul_f32 v239, v239, v231
v_cvt_pk_bf16_f32 v1, v238, v239
v_mfma_f32_32x32x16_bf16 v[96:111], v[144:147], a[132:135], v[96:111]
ds_read_b64_tr_b16 v[160:161], v7 offset:0
ds_read_b64_tr_b16 v[162:163], v7 offset:512
ds_read_b64_tr_b16 v[164:165], v8 offset:0
ds_read_b64_tr_b16 v[166:167], v8 offset:512
ds_read_b128 a[144:147], v3 offset:41280
ds_read_b128 a[148:151], v3 offset:41792
v_lshlrev_b32 v238, 16, v1
v_mfma_f32_32x32x16_bf16 v[112:127], v[148:151], a[128:131], v[112:127]
s_cmp_ge_u32 s7, 4
s_cselect_b32 s27, 0, 2048
s_add_u32 s27, s27, 2048
s_add_u32 s92, s84, s27
buffer_load_dwordx4 a[64:67], v19, s[76:79], s92 offen offset:0 sc1
v_and_b32 v239, 0xffff0000, v1
v_mul_f32 v238, v238, v236
v_mul_f32 v239, v239, v237
v_cvt_pk_bf16_f32 v1, v238, v239
v_mfma_f32_32x32x16_bf16 v[128:143], v[148:151], a[132:135], v[128:143]
v_lshlrev_b32 v238, 16, v1
v_and_b32 v239, 0xffff0000, v1
v_add_f32 v250, v250, v238
v_add_f32 v251, v251, v239
v_lshlrev_b32 v252, 16, v222
s_waitcnt lgkmcnt(6)
v_mfma_f32_32x32x16_bf16 v[80:95], v[152:155], a[136:139], v[80:95]
buffer_load_dwordx4 a[68:71], v19, s[76:79], s92 offen offset:1024 sc1
v_and_b32 v253, 0xffff0000, v222
v_sub_f32 v238, v252, v232
v_sub_f32 v239, v253, v232
v_cvt_pk_bf16_f32 v1, v238, v239
v_lshlrev_b32_e64 v238, 16, v1
v_mfma_f32_32x32x16_bf16 v[96:111], v[152:155], a[140:143], v[96:111]
ds_read_b64_tr_b16 v[168:169], v7 offset:2048
ds_read_b64_tr_b16 v[170:171], v7 offset:2560
ds_read_b64_tr_b16 v[172:173], v8 offset:2048
ds_read_b64_tr_b16 v[174:175], v8 offset:2560
ds_read_b128 a[152:155], v3 offset:45408
ds_read_b128 a[156:159], v3 offset:45920
v_and_b32 v239, 0xffff0000, v1
v_mfma_f32_32x32x16_bf16 v[112:127], v[156:159], a[136:139], v[112:127]
s_cmp_ge_u32 s7, 6
s_cselect_b32 s27, 0, 2048
s_add_u32 s27, s27, 4096
s_add_u32 s92, s84, s27
buffer_load_dwordx4 a[72:75], v19, s[76:79], s92 offen offset:0 sc1
v_mul_f32 v238, v238, v233
v_mul_f32 v239, v239, v233
v_cvt_pk_bf16_f32 v1, v238, v239
v_lshlrev_b32 v238, 16, v1
v_mfma_f32_32x32x16_bf16 v[128:143], v[156:159], a[140:143], v[128:143]
v_and_b32 v239, 0xffff0000, v1
v_mul_f32 v238, v238, v234
v_mul_f32 v239, v239, v235
v_cvt_pk_bf16_f32 v1, v238, v239
v_lshlrev_b32 v238, 16, v1
s_waitcnt lgkmcnt(6)
v_mfma_f32_32x32x16_bf16 v[80:95], v[160:163], a[144:147], v[80:95]
buffer_load_dwordx4 a[76:79], v19, s[76:79], s92 offen offset:1024 sc1
v_and_b32 v239, 0xffff0000, v1
v_add_f32 v252, v252, v238
v_add_f32 v253, v253, v239
v_lshlrev_b32 v254, 16, v223
v_and_b32 v255, 0xffff0000, v223
v_mfma_f32_32x32x16_bf16 v[96:111], v[160:163], a[148:151], v[96:111]
v_sub_f32 v238, v254, v232
v_sub_f32 v239, v255, v232
v_cvt_pk_bf16_f32 v1, v238, v239
v_lshlrev_b32 v238, 16, v1
v_and_b32 v239, 0xffff0000, v1
v_mfma_f32_32x32x16_bf16 v[112:127], v[164:167], a[144:147], v[112:127]
s_cmp_ge_u32 s7, 8
s_cselect_b32 s27, 0, 2048
s_add_u32 s27, s27, 6144
s_add_u32 s92, s84, s27
buffer_load_dwordx4 a[80:83], v19, s[76:79], s92 offen offset:0 sc1
v_mul_f32 v238, v238, v233
v_mul_f32 v239, v239, v233
v_cvt_pk_bf16_f32 v1, v238, v239
v_lshlrev_b32 v238, 16, v1
v_mfma_f32_32x32x16_bf16 v[128:143], v[164:167], a[148:151], v[128:143]
v_and_b32 v239, 0xffff0000, v1
v_mul_f32 v238, v238, v236
v_mul_f32 v239, v239, v237
v_cvt_pk_bf16_f32 v1, v238, v239
v_lshlrev_b32 v238, 16, v1
s_waitcnt lgkmcnt(0)
v_mfma_f32_32x32x16_bf16 v[80:95], v[168:171], a[152:155], v[80:95]
buffer_load_dwordx4 a[84:87], v19, s[76:79], s92 offen offset:1024 sc1
v_and_b32 v239, 0xffff0000, v1
v_add_f32 v254, v254, v238
v_add_f32 v255, v255, v239
v_mfma_f32_32x32x16_bf16 v[96:111], v[168:171], a[156:159], v[96:111]
v_mfma_f32_32x32x16_bf16 v[112:127], v[172:175], a[152:155], v[112:127]
s_cmp_ge_u32 s7, 10
s_cselect_b32 s27, 0, 2048
s_add_u32 s27, s27, 8192
s_add_u32 s92, s84, s27
buffer_load_dwordx4 a[88:91], v19, s[76:79], s92 offen offset:0 sc1
v_mfma_f32_32x32x16_bf16 v[128:143], v[172:175], a[156:159], v[128:143]
v_rcp_f32 v32, v30
v_rcp_f32 v33, v31
v_mul_f32 v32, 0xbfb8aa3b, v32
v_mul_f32 v33, 0xbfb8aa3b, v33
s_lshl_b32 s3, s87, 1
s_add_u32 s11, s3, s86
s_mul_i32 s11, s11, 12288
v_add_u32 v3, s11, v19
s_add_u32 s3, s3, s8
s_mul_i32 s11, s3, 12288
s_lshl_b32 s12, s86, 11
s_add_u32 s11, s11, s12
v_add_u32 v4, s11, v19
s_lshl_b32 s3, s4, 12
s_add_u32 s3, s3, 139264
v_add_u32 v8, s3, v19
s_sub_u32 s3, s3, s56
s_add_u32 s3, s3, s12
v_lshlrev_b32 v1, 9, v38
v_sub_u32 v17, v17, v1
v_add_u32 v17, s3, v17
v_xor_b32 v18, 64, v17
s_barrier
v_pk_mul_f32 v[144:145], v[80:81], v[32:33] op_sel_hi:[1,0]
v_pk_mul_f32 v[146:147], v[82:83], v[32:33] op_sel_hi:[1,0]
v_pk_mul_f32 v[148:149], v[84:85], v[32:33] op_sel_hi:[1,0]
v_pk_mul_f32 v[150:151], v[86:87], v[32:33] op_sel_hi:[1,0]
v_exp_f32 v144, v144
v_exp_f32 v145, v145
v_exp_f32 v146, v146
v_exp_f32 v147, v147
v_exp_f32 v148, v148
v_exp_f32 v149, v149
v_exp_f32 v150, v150
v_exp_f32 v151, v151
buffer_load_dwordx4 a[92:95], v19, s[76:79], s92 offen offset:1024 sc1
v_pk_fma_f32 v[144:145], v[144:145], v[30:31], v[30:31] op_sel_hi:[1,0,0]
v_pk_fma_f32 v[146:147], v[146:147], v[30:31], v[30:31] op_sel_hi:[1,0,0]
v_pk_fma_f32 v[148:149], v[148:149], v[30:31], v[30:31] op_sel_hi:[1,0,0]
v_pk_fma_f32 v[150:151], v[150:151], v[30:31], v[30:31] op_sel_hi:[1,0,0]
v_rcp_f32 v144, v144
v_rcp_f32 v145, v145
v_rcp_f32 v146, v146
v_rcp_f32 v147, v147
v_rcp_f32 v148, v148
v_rcp_f32 v149, v149
v_rcp_f32 v150, v150
v_rcp_f32 v151, v151
buffer_load_dwordx4 v[176:179], v208, s[72:75], 0 offen sc1
buffer_load_dwordx4 v[180:183], v209, s[72:75], 0 offen sc1
v_pk_mul_f32 v[144:145], v[144:145], v[80:81]
v_pk_mul_f32 v[146:147], v[146:147], v[82:83]
v_pk_mul_f32 v[148:149], v[148:149], v[84:85]
v_pk_mul_f32 v[150:151], v[150:151], v[86:87]
v_cvt_pk_bf16_f32 v80, v144, v145
v_cvt_pk_bf16_f32 v81, v146, v147
v_cvt_pk_bf16_f32 v82, v148, v149
v_cvt_pk_bf16_f32 v83, v150, v151
buffer_store_dwordx4 v[80:83], v19, s[64:67], s46 offen offset:0 sc1
ds_write_b128 v3, v[80:83] offset:0
ds_write_b128 v8, a[160:163] offset:0
ds_write_b128 v8, a[164:167] offset:1024
v_pk_mul_f32 v[144:145], v[88:89], v[32:33] op_sel_hi:[1,0]
v_pk_mul_f32 v[146:147], v[90:91], v[32:33] op_sel_hi:[1,0]
v_pk_mul_f32 v[148:149], v[92:93], v[32:33] op_sel_hi:[1,0]
v_pk_mul_f32 v[150:151], v[94:95], v[32:33] op_sel_hi:[1,0]
v_exp_f32 v144, v144
v_exp_f32 v145, v145
v_exp_f32 v146, v146
v_exp_f32 v147, v147
v_exp_f32 v148, v148
v_exp_f32 v149, v149
v_exp_f32 v150, v150
v_exp_f32 v151, v151
s_cmp_ge_u32 s7, 12
s_cselect_b32 s27, 0, 2048
s_add_u32 s27, s27, 10240
s_add_u32 s92, s84, s27
buffer_load_dwordx4 a[96:99], v19, s[76:79], s92 offen offset:0 sc1
v_pk_fma_f32 v[144:145], v[144:145], v[30:31], v[30:31] op_sel_hi:[1,0,0]
v_pk_fma_f32 v[146:147], v[146:147], v[30:31], v[30:31] op_sel_hi:[1,0,0]
v_pk_fma_f32 v[148:149], v[148:149], v[30:31], v[30:31] op_sel_hi:[1,0,0]
v_pk_fma_f32 v[150:151], v[150:151], v[30:31], v[30:31] op_sel_hi:[1,0,0]
v_rcp_f32 v144, v144
v_rcp_f32 v145, v145
v_rcp_f32 v146, v146
v_rcp_f32 v147, v147
v_rcp_f32 v148, v148
v_rcp_f32 v149, v149
v_rcp_f32 v150, v150
v_rcp_f32 v151, v151
buffer_load_dwordx4 v[184:187], v210, s[72:75], 0 offen sc1
buffer_load_dwordx4 v[188:191], v211, s[72:75], 0 offen sc1
v_pk_mul_f32 v[144:145], v[144:145], v[88:89]
v_pk_mul_f32 v[146:147], v[146:147], v[90:91]
v_pk_mul_f32 v[148:149], v[148:149], v[92:93]
v_pk_mul_f32 v[150:151], v[150:151], v[94:95]
v_cvt_pk_bf16_f32 v88, v144, v145
v_cvt_pk_bf16_f32 v89, v146, v147
v_cvt_pk_bf16_f32 v90, v148, v149
v_cvt_pk_bf16_f32 v91, v150, v151
buffer_store_dwordx4 v[88:91], v19, s[64:67], s46 offen offset:2048 sc1
ds_write_b128 v3, v[88:91] offset:2048
ds_read_b64_tr_b16 a[160:161], v17
ds_read_b64_tr_b16 a[162:163], v17 offset:1024
v_pk_mul_f32 v[144:145], v[96:97], v[32:33] op_sel:[0,1]
v_pk_mul_f32 v[146:147], v[98:99], v[32:33] op_sel:[0,1]
v_pk_mul_f32 v[148:149], v[100:101], v[32:33] op_sel:[0,1]
v_pk_mul_f32 v[150:151], v[102:103], v[32:33] op_sel:[0,1]
v_exp_f32 v144, v144
v_exp_f32 v145, v145
v_exp_f32 v146, v146
v_exp_f32 v147, v147
v_exp_f32 v148, v148
v_exp_f32 v149, v149
v_exp_f32 v150, v150
v_exp_f32 v151, v151
buffer_load_dwordx4 a[100:103], v19, s[76:79], s92 offen offset:1024 sc1
v_pk_fma_f32 v[144:145], v[144:145], v[30:31], v[30:31] op_sel:[0,1,1]
v_pk_fma_f32 v[146:147], v[146:147], v[30:31], v[30:31] op_sel:[0,1,1]
v_pk_fma_f32 v[148:149], v[148:149], v[30:31], v[30:31] op_sel:[0,1,1]
v_pk_fma_f32 v[150:151], v[150:151], v[30:31], v[30:31] op_sel:[0,1,1]
v_rcp_f32 v144, v144
v_rcp_f32 v145, v145
v_rcp_f32 v146, v146
v_rcp_f32 v147, v147
v_rcp_f32 v148, v148
v_rcp_f32 v149, v149
v_rcp_f32 v150, v150
v_rcp_f32 v151, v151
buffer_load_dwordx4 v[192:195], v212, s[72:75], 0 offen sc1
buffer_load_dwordx4 v[196:199], v213, s[72:75], 0 offen sc1
v_pk_mul_f32 v[144:145], v[144:145], v[96:97]
v_pk_mul_f32 v[146:147], v[146:147], v[98:99]
v_pk_mul_f32 v[148:149], v[148:149], v[100:101]
v_pk_mul_f32 v[150:151], v[150:151], v[102:103]
v_cvt_pk_bf16_f32 v96, v144, v145
v_cvt_pk_bf16_f32 v97, v146, v147
v_cvt_pk_bf16_f32 v98, v148, v149
v_cvt_pk_bf16_f32 v99, v150, v151
buffer_store_dwordx4 v[96:99], v19, s[64:67], s46 offen offset:1024 sc1
ds_write_b128 v3, v[96:99] offset:1024
ds_read_b64_tr_b16 a[164:165], v18
ds_read_b64_tr_b16 a[166:167], v18 offset:1024
v_pk_mul_f32 v[144:145], v[104:105], v[32:33] op_sel:[0,1]
v_pk_mul_f32 v[146:147], v[106:107], v[32:33] op_sel:[0,1]
v_pk_mul_f32 v[148:149], v[108:109], v[32:33] op_sel:[0,1]
v_pk_mul_f32 v[150:151], v[110:111], v[32:33] op_sel:[0,1]
v_exp_f32 v144, v144
v_exp_f32 v145, v145
v_exp_f32 v146, v146
v_exp_f32 v147, v147
v_exp_f32 v148, v148
v_exp_f32 v149, v149
v_exp_f32 v150, v150
v_exp_f32 v151, v151
s_cmp_ge_u32 s7, 14
s_cselect_b32 s27, 0, 2048
s_add_u32 s27, s27, 12288
s_add_u32 s92, s84, s27
buffer_load_dwordx4 a[104:107], v19, s[76:79], s92 offen offset:0 sc1
v_pk_fma_f32 v[144:145], v[144:145], v[30:31], v[30:31] op_sel:[0,1,1]
v_pk_fma_f32 v[146:147], v[146:147], v[30:31], v[30:31] op_sel:[0,1,1]
v_pk_fma_f32 v[148:149], v[148:149], v[30:31], v[30:31] op_sel:[0,1,1]
v_pk_fma_f32 v[150:151], v[150:151], v[30:31], v[30:31] op_sel:[0,1,1]
v_rcp_f32 v144, v144
v_rcp_f32 v145, v145
v_rcp_f32 v146, v146
v_rcp_f32 v147, v147
v_rcp_f32 v148, v148
v_rcp_f32 v149, v149
v_rcp_f32 v150, v150
v_rcp_f32 v151, v151
buffer_load_dwordx4 v[200:203], v214, s[72:75], 0 offen sc1
buffer_load_dwordx4 v[204:207], v215, s[72:75], 0 offen sc1
v_pk_mul_f32 v[144:145], v[144:145], v[104:105]
v_pk_mul_f32 v[146:147], v[146:147], v[106:107]
v_pk_mul_f32 v[148:149], v[148:149], v[108:109]
v_pk_mul_f32 v[150:151], v[150:151], v[110:111]
v_cvt_pk_bf16_f32 v104, v144, v145
v_cvt_pk_bf16_f32 v105, v146, v147
v_cvt_pk_bf16_f32 v106, v148, v149
v_cvt_pk_bf16_f32 v107, v150, v151
buffer_store_dwordx4 v[104:107], v19, s[64:67], s46 offen offset:3072 sc1
ds_write_b128 v3, v[104:107] offset:3072
ds_write_b128 v8, a[168:171] offset:0
ds_write_b128 v8, a[172:175] offset:1024
v_pk_mul_f32 v[144:145], v[112:113], v[32:33] op_sel_hi:[1,0]
v_pk_mul_f32 v[146:147], v[114:115], v[32:33] op_sel_hi:[1,0]
v_pk_mul_f32 v[148:149], v[116:117], v[32:33] op_sel_hi:[1,0]
v_pk_mul_f32 v[150:151], v[118:119], v[32:33] op_sel_hi:[1,0]
v_exp_f32 v144, v144
v_exp_f32 v145, v145
v_exp_f32 v146, v146
v_exp_f32 v147, v147
v_exp_f32 v148, v148
v_exp_f32 v149, v149
v_exp_f32 v150, v150
v_exp_f32 v151, v151
buffer_load_dwordx4 a[108:111], v19, s[76:79], s92 offen offset:1024 sc1
v_pk_fma_f32 v[144:145], v[144:145], v[30:31], v[30:31] op_sel_hi:[1,0,0]
v_pk_fma_f32 v[146:147], v[146:147], v[30:31], v[30:31] op_sel_hi:[1,0,0]
v_pk_fma_f32 v[148:149], v[148:149], v[30:31], v[30:31] op_sel_hi:[1,0,0]
v_pk_fma_f32 v[150:151], v[150:151], v[30:31], v[30:31] op_sel_hi:[1,0,0]
v_rcp_f32 v144, v144
v_rcp_f32 v145, v145
v_rcp_f32 v146, v146
v_rcp_f32 v147, v147
v_rcp_f32 v148, v148
v_rcp_f32 v149, v149
v_rcp_f32 v150, v150
v_rcp_f32 v151, v151
s_cmp_ge_u32 s7, 16
s_cselect_b32 s27, 0, 2048
s_add_u32 s27, s27, 14336
s_add_u32 s92, s84, s27
buffer_load_dwordx4 a[112:115], v19, s[76:79], s92 offen offset:0 sc1
v_pk_mul_f32 v[144:145], v[144:145], v[112:113]
v_pk_mul_f32 v[146:147], v[146:147], v[114:115]
v_pk_mul_f32 v[148:149], v[148:149], v[116:117]
v_pk_mul_f32 v[150:151], v[150:151], v[118:119]
v_cvt_pk_bf16_f32 v112, v144, v145
v_cvt_pk_bf16_f32 v113, v146, v147
v_cvt_pk_bf16_f32 v114, v148, v149
v_cvt_pk_bf16_f32 v115, v150, v151
buffer_store_dwordx4 v[112:115], v19, s[64:67], s47 offen offset:0 sc1
ds_write_b128 v3, v[112:115] offset:4096
ds_read_b64_tr_b16 a[168:169], v17
ds_read_b64_tr_b16 a[170:171], v17 offset:1024
v_pk_mul_f32 v[144:145], v[120:121], v[32:33] op_sel_hi:[1,0]
v_pk_mul_f32 v[146:147], v[122:123], v[32:33] op_sel_hi:[1,0]
v_pk_mul_f32 v[148:149], v[124:125], v[32:33] op_sel_hi:[1,0]
v_pk_mul_f32 v[150:151], v[126:127], v[32:33] op_sel_hi:[1,0]
v_exp_f32 v144, v144
v_exp_f32 v145, v145
v_exp_f32 v146, v146
v_exp_f32 v147, v147
v_exp_f32 v148, v148
v_exp_f32 v149, v149
v_exp_f32 v150, v150
v_exp_f32 v151, v151
buffer_load_dwordx4 a[116:119], v19, s[76:79], s92 offen offset:1024 sc1
v_pk_fma_f32 v[144:145], v[144:145], v[30:31], v[30:31] op_sel_hi:[1,0,0]
v_pk_fma_f32 v[146:147], v[146:147], v[30:31], v[30:31] op_sel_hi:[1,0,0]
v_pk_fma_f32 v[148:149], v[148:149], v[30:31], v[30:31] op_sel_hi:[1,0,0]
v_pk_fma_f32 v[150:151], v[150:151], v[30:31], v[30:31] op_sel_hi:[1,0,0]
v_rcp_f32 v144, v144
v_rcp_f32 v145, v145
v_rcp_f32 v146, v146
v_rcp_f32 v147, v147
v_rcp_f32 v148, v148
v_rcp_f32 v149, v149
v_rcp_f32 v150, v150
v_rcp_f32 v151, v151
s_cmp_ge_u32 s7, 18
s_cselect_b32 s57, 0, 114688
s_add_u32 s57, s57, 917504
s_add_u32 s28, s57, s25
buffer_load_dwordx4 a[120:123], v11, s[80:83], s28 offen
v_pk_mul_f32 v[144:145], v[144:145], v[120:121]
v_pk_mul_f32 v[146:147], v[146:147], v[122:123]
v_pk_mul_f32 v[148:149], v[148:149], v[124:125]
v_pk_mul_f32 v[150:151], v[150:151], v[126:127]
v_cvt_pk_bf16_f32 v120, v144, v145
v_cvt_pk_bf16_f32 v121, v146, v147
v_cvt_pk_bf16_f32 v122, v148, v149
v_cvt_pk_bf16_f32 v123, v150, v151
buffer_store_dwordx4 v[120:123], v19, s[64:67], s47 offen offset:2048 sc1
ds_write_b128 v3, v[120:123] offset:6144
ds_read_b64_tr_b16 a[172:173], v18
ds_read_b64_tr_b16 a[174:175], v18 offset:1024
v_pk_mul_f32 v[144:145], v[128:129], v[32:33] op_sel:[0,1]
v_pk_mul_f32 v[146:147], v[130:131], v[32:33] op_sel:[0,1]
v_pk_mul_f32 v[148:149], v[132:133], v[32:33] op_sel:[0,1]
v_pk_mul_f32 v[150:151], v[134:135], v[32:33] op_sel:[0,1]
v_exp_f32 v144, v144
v_exp_f32 v145, v145
v_exp_f32 v146, v146
v_exp_f32 v147, v147
v_exp_f32 v148, v148
v_exp_f32 v149, v149
v_exp_f32 v150, v150
v_exp_f32 v151, v151
buffer_load_dwordx4 a[124:127], v37, s[80:83], s28 offen
v_pk_fma_f32 v[144:145], v[144:145], v[30:31], v[30:31] op_sel:[0,1,1]
v_pk_fma_f32 v[146:147], v[146:147], v[30:31], v[30:31] op_sel:[0,1,1]
v_pk_fma_f32 v[148:149], v[148:149], v[30:31], v[30:31] op_sel:[0,1,1]
v_pk_fma_f32 v[150:151], v[150:151], v[30:31], v[30:31] op_sel:[0,1,1]
v_rcp_f32 v144, v144
v_rcp_f32 v145, v145
v_rcp_f32 v146, v146
v_rcp_f32 v147, v147
v_rcp_f32 v148, v148
v_rcp_f32 v149, v149
v_rcp_f32 v150, v150
v_rcp_f32_e64 v151, v151
s_add_u32 s28, s57, s25
s_add_u32 s28, s28, 28672
buffer_load_dwordx4 a[128:131], v11, s[80:83], s28 offen
v_pk_mul_f32 v[144:145], v[144:145], v[128:129]
v_pk_mul_f32 v[146:147], v[146:147], v[130:131]
v_pk_mul_f32 v[148:149], v[148:149], v[132:133]
v_pk_mul_f32 v[150:151], v[150:151], v[134:135]
v_cvt_pk_bf16_f32 v128, v144, v145
v_cvt_pk_bf16_f32 v129, v146, v147
v_cvt_pk_bf16_f32 v130, v148, v149
v_cvt_pk_bf16_f32 v131, v150, v151
buffer_store_dwordx4 v[128:131], v19, s[64:67], s47 offen offset:1024 sc1
ds_write_b128 v3, v[128:131] offset:5120
ds_write_b128 v8, a[176:179] offset:0
ds_write_b128 v8, a[180:183] offset:1024
v_pk_mul_f32 v[144:145], v[136:137], v[32:33] op_sel:[0,1]
v_pk_mul_f32 v[146:147], v[138:139], v[32:33] op_sel:[0,1]
v_pk_mul_f32 v[148:149], v[140:141], v[32:33] op_sel:[0,1]
v_pk_mul_f32 v[150:151], v[142:143], v[32:33] op_sel:[0,1]
v_exp_f32 v144, v144
v_exp_f32 v145, v145
v_exp_f32 v146, v146
v_exp_f32 v147, v147
v_exp_f32 v148, v148
v_exp_f32 v149, v149
v_exp_f32 v150, v150
v_exp_f32 v151, v151
buffer_load_dwordx4 a[132:135], v37, s[80:83], s28 offen
v_pk_fma_f32 v[144:145], v[144:145], v[30:31], v[30:31] op_sel:[0,1,1]
v_pk_fma_f32 v[146:147], v[146:147], v[30:31], v[30:31] op_sel:[0,1,1]
v_pk_fma_f32 v[148:149], v[148:149], v[30:31], v[30:31] op_sel:[0,1,1]
v_pk_fma_f32 v[150:151], v[150:151], v[30:31], v[30:31] op_sel:[0,1,1]
v_rcp_f32 v144, v144
v_rcp_f32 v145, v145
v_rcp_f32 v146, v146
v_rcp_f32 v147, v147
v_rcp_f32 v148, v148
v_rcp_f32 v149, v149
v_rcp_f32 v150, v150
v_rcp_f32 v151, v151
s_cmp_ge_u32 s7, 18
s_cselect_b32 s27, 0, 2048
s_add_u32 s27, s27, 16384
s_add_u32 s92, s84, s27
buffer_load_dwordx4 a[136:139], v19, s[76:79], s92 offen offset:0 sc1
v_pk_mul_f32 v[144:145], v[144:145], v[136:137]
v_pk_mul_f32 v[146:147], v[146:147], v[138:139]
v_pk_mul_f32 v[148:149], v[148:149], v[140:141]
v_pk_mul_f32 v[150:151], v[150:151], v[142:143]
v_cvt_pk_bf16_f32 v136, v144, v145
v_cvt_pk_bf16_f32 v137, v146, v147
v_cvt_pk_bf16_f32 v138, v148, v149
v_cvt_pk_bf16_f32 v139, v150, v151
buffer_store_dwordx4 v[136:139], v19, s[64:67], s47 offen offset:3072 sc1
ds_write_b128 v3, v[136:139] offset:7168
ds_read_b64_tr_b16 a[176:177], v17
ds_read_b64_tr_b16 a[178:179], v17 offset:1024
v_and_b32 v154, 1, v0
v_lshl_add_u32 v154, v38, 1, v154
s_add_u32 s3, s93, 3
v_sub_u32 v154, s3, v154
v_lshrrev_b32 v154, 2, v154
v_lshlrev_b32 v154, 1, v154
v_mul_lo_u32 v154, v154, v40
s_waitcnt vmcnt(8)
v_add3_u32 v152, v177, v179, v181
v_add3_u32 v153, v183, v185, v187
v_add3_u32 v152, v152, v189, v191
v_add3_u32 v153, v153, v193, v195
v_add3_u32 v152, v152, v197, v199
v_add3_u32 v153, v153, v201, v203
v_add3_u32 v152, v152, v205, v207
v_add_u32 v152, v152, v153
v_cmp_eq_u32 vcc, v152, v154
s_nop 0
s_cmp_eq_u64 vcc, -1
s_cbranch_scc0 L_rt_lb
L_bk_lb:
v_fma_f32 v43, v26, v204, v200
v_fma_f32 v44, v26, v206, v202
v_fma_f32 v43, -v27, v206, v43
v_fmac_f32 v44, v27, v204
v_fma_f32 v41, v26, v43, v196
v_fma_f32 v42, v26, v44, v198
v_fma_f32 v41, -v27, v44, v41
v_fmac_f32 v42, v27, v43
v_fma_f32 v43, v26, v41, v192
v_fma_f32 v44, v26, v42, v194
v_fma_f32 v43, -v27, v42, v43
v_fmac_f32 v44, v27, v41
v_fma_f32 v41, v26, v43, v188
v_fma_f32 v42, v26, v44, v190
v_fma_f32 v41, -v27, v44, v41
v_fmac_f32 v42, v27, v43
v_fma_f32 v43, v26, v41, v184
v_fma_f32 v44, v26, v42, v186
v_fma_f32 v43, -v27, v42, v43
v_fmac_f32 v44, v27, v41
v_fma_f32 v41, v26, v43, v180
v_fma_f32 v42, v26, v44, v182
v_fma_f32 v41, -v27, v44, v41
v_fmac_f32 v42, v27, v43
v_fma_f32 v43, v26, v41, v176
v_fma_f32 v44, v26, v42, v178
v_fma_f32 v43, -v27, v42, v43
v_fmac_f32 v44, v27, v41
v_mul_f32 v41, v28, v43
v_mul_f32 v42, v28, v44
v_fma_f32 v41, -v29, v44, v41
v_fmac_f32 v42, v29, v43
v_and_b32 v1, 1, v0
v_cmp_eq_u32 vcc, 0, v1
v_add_f32_dpp v41, v41, v41 quad_perm:[1,0,3,2] row_mask:0xf bank_mask:0xf
v_add_f32_dpp v42, v42, v42 quad_perm:[1,0,3,2] row_mask:0xf bank_mask:0xf
v_cndmask_b32 v43, v42, v41, vcc
v_cmp_eq_u32 vcc, 0, v38
v_mov_b32 v44, v43
v_mul_u32_u24 v46, 144, v36
v_lshl_add_u32 v46, v38, 6, v46
v_permlane32_swap_b32 v43, v44
v_add_u32 v46, s58, v46
v_add_f32 v44, v43, v44
v_bfe_u32 v47, v0, 2, 2
v_lshl_add_u32 v47, v38, 3, v47
v_fma_f32 v41, v24, v44, v35
s_nop 1
v_fmac_f32_dpp v41, v44, v25 quad_perm:[1,0,3,2] row_mask:0xf bank_mask:0xf
v_mul_u32_u24 v47, 144, v47
v_cndmask_b32 v41, v41, v44, vcc
v_lshl_add_u32 v47, v1, 6, v47
v_bfe_u32 v1, v0, 1, 1
v_fma_f32 v42, v22, v41, v34
s_nop 1
v_fmac_f32_dpp v42, v41, v23 quad_perm:[1,0,3,2] row_mask:0xf bank_mask:0xf
v_lshl_add_u32 v47, v1, 3, v47
v_fma_f32 v48, v20, v41, v48
v_fma_f32 v64, v20, v42, v64
s_nop 0
v_fmac_f32_dpp v48, v41, v21 quad_perm:[1,0,3,2] row_mask:0xf bank_mask:0xf
v_fmac_f32_dpp v64, v42, v21 quad_perm:[1,0,3,2] row_mask:0xf bank_mask:0xf
v_fma_f32 v49, v20, v48, v49
v_fma_f32 v65, v20, v64, v65
s_nop 0
v_fmac_f32_dpp v49, v48, v21 quad_perm:[1,0,3,2] row_mask:0xf bank_mask:0xf
v_fmac_f32_dpp v65, v64, v21 quad_perm:[1,0,3,2] row_mask:0xf bank_mask:0xf
v_fma_f32 v50, v20, v49, v50
v_fma_f32 v66, v20, v65, v66
s_nop 0
v_fmac_f32_dpp v50, v49, v21 quad_perm:[1,0,3,2] row_mask:0xf bank_mask:0xf
v_fmac_f32_dpp v66, v65, v21 quad_perm:[1,0,3,2] row_mask:0xf bank_mask:0xf
v_fma_f32 v51, v20, v50, v51
v_fma_f32 v67, v20, v66, v67
s_nop 0
v_fmac_f32_dpp v51, v50, v21 quad_perm:[1,0,3,2] row_mask:0xf bank_mask:0xf
v_fmac_f32_dpp v67, v66, v21 quad_perm:[1,0,3,2] row_mask:0xf bank_mask:0xf
v_fma_f32 v52, v20, v51, v52
v_fma_f32 v68, v20, v67, v68
s_nop 0
v_fmac_f32_dpp v52, v51, v21 quad_perm:[1,0,3,2] row_mask:0xf bank_mask:0xf
v_fmac_f32_dpp v68, v67, v21 quad_perm:[1,0,3,2] row_mask:0xf bank_mask:0xf
v_fma_f32 v53, v20, v52, v53
v_fma_f32 v69, v20, v68, v69
s_nop 0
v_fmac_f32_dpp v53, v52, v21 quad_perm:[1,0,3,2] row_mask:0xf bank_mask:0xf
v_fmac_f32_dpp v69, v68, v21 quad_perm:[1,0,3,2] row_mask:0xf bank_mask:0xf
v_fma_f32 v54, v20, v53, v54
v_fma_f32 v70, v20, v69, v70
s_nop 0
v_fmac_f32_dpp v54, v53, v21 quad_perm:[1,0,3,2] row_mask:0xf bank_mask:0xf
v_fmac_f32_dpp v70, v69, v21 quad_perm:[1,0,3,2] row_mask:0xf bank_mask:0xf
v_fma_f32 v55, v20, v54, v55
v_fma_f32 v71, v20, v70, v71
s_nop 0
v_fmac_f32_dpp v55, v54, v21 quad_perm:[1,0,3,2] row_mask:0xf bank_mask:0xf
v_fmac_f32_dpp v71, v70, v21 quad_perm:[1,0,3,2] row_mask:0xf bank_mask:0xf
v_fma_f32 v56, v20, v55, v56
v_fma_f32 v72, v20, v71, v72
s_nop 0
v_fmac_f32_dpp v56, v55, v21 quad_perm:[1,0,3,2] row_mask:0xf bank_mask:0xf
v_fmac_f32_dpp v72, v71, v21 quad_perm:[1,0,3,2] row_mask:0xf bank_mask:0xf
v_fma_f32 v57, v20, v56, v57
v_fma_f32 v73, v20, v72, v73
s_nop 0
v_fmac_f32_dpp v57, v56, v21 quad_perm:[1,0,3,2] row_mask:0xf bank_mask:0xf
v_fmac_f32_dpp v73, v72, v21 quad_perm:[1,0,3,2] row_mask:0xf bank_mask:0xf
v_fma_f32 v58, v20, v57, v58
v_fma_f32 v74, v20, v73, v74
s_nop 0
v_fmac_f32_dpp v58, v57, v21 quad_perm:[1,0,3,2] row_mask:0xf bank_mask:0xf
v_fmac_f32_dpp v74, v73, v21 quad_perm:[1,0,3,2] row_mask:0xf bank_mask:0xf
v_fma_f32 v59, v20, v58, v59
v_fma_f32 v75, v20, v74, v75
s_nop 0
v_fmac_f32_dpp v59, v58, v21 quad_perm:[1,0,3,2] row_mask:0xf bank_mask:0xf
v_fmac_f32_dpp v75, v74, v21 quad_perm:[1,0,3,2] row_mask:0xf bank_mask:0xf
v_fma_f32 v60, v20, v59, v60
v_fma_f32 v76, v20, v75, v76
s_nop 0
v_fmac_f32_dpp v60, v59, v21 quad_perm:[1,0,3,2] row_mask:0xf bank_mask:0xf
v_fmac_f32_dpp v76, v75, v21 quad_perm:[1,0,3,2] row_mask:0xf bank_mask:0xf
v_fma_f32 v61, v20, v60, v61
v_fma_f32 v77, v20, v76, v77
s_nop 0
v_fmac_f32_dpp v61, v60, v21 quad_perm:[1,0,3,2] row_mask:0xf bank_mask:0xf
v_fmac_f32_dpp v77, v76, v21 quad_perm:[1,0,3,2] row_mask:0xf bank_mask:0xf
v_fma_f32 v62, v20, v61, v62
v_fma_f32 v78, v20, v77, v78
s_nop 0
v_fmac_f32_dpp v62, v61, v21 quad_perm:[1,0,3,2] row_mask:0xf bank_mask:0xf
v_fmac_f32_dpp v78, v77, v21 quad_perm:[1,0,3,2] row_mask:0xf bank_mask:0xf
v_fma_f32 v63, v20, v62, v63
v_fma_f32 v79, v20, v78, v79
s_nop 0
v_fmac_f32_dpp v63, v62, v21 quad_perm:[1,0,3,2] row_mask:0xf bank_mask:0xf
v_fmac_f32_dpp v79, v78, v21 quad_perm:[1,0,3,2] row_mask:0xf bank_mask:0xf
v_bfe_u32 v1, v0, 4, 1
v_lshl_add_u32 v47, v1, 4, v47
v_add_u32_e64 v47, s58, v47
v_cvt_pk_bf16_f32 v144, v48, v49
v_cvt_pk_bf16_f32 v145, v50, v51
v_cvt_pk_bf16_f32 v146, v52, v53
v_cvt_pk_bf16_f32 v147, v54, v55
ds_write_b128 v46, v[144:147] offset:0
v_cvt_pk_bf16_f32 v148, v56, v57
v_cvt_pk_bf16_f32 v149, v58, v59
v_cvt_pk_bf16_f32 v150, v60, v61
v_cvt_pk_bf16_f32 v151, v62, v63
ds_write_b128 v46, v[148:151] offset:16
v_cvt_pk_bf16_f32 v152, v64, v65
v_cvt_pk_bf16_f32 v153, v66, v67
v_cvt_pk_bf16_f32 v154, v68, v69
v_cvt_pk_bf16_f32 v155, v70, v71
ds_write_b128 v46, v[152:155] offset:32
v_cvt_pk_bf16_f32 v156, v72, v73
v_cvt_pk_bf16_f32 v157, v74, v75
v_cvt_pk_bf16_f32 v158, v76, v77
v_cvt_pk_bf16_f32 v159, v78, v79
ds_write_b128 v46, v[156:159] offset:48
ds_read_b64_tr_b16 v[160:161], v47 offset:0
ds_read_b64_tr_b16 v[162:163], v47 offset:576
ds_read_b64_tr_b16 v[164:165], v47 offset:32
ds_read_b64_tr_b16 v[166:167], v47 offset:608
ds_read_b64_tr_b16 v[168:169], v47 offset:2304
ds_read_b64_tr_b16 v[170:171], v47 offset:2880
ds_read_b64_tr_b16 v[172:173], v47 offset:2336
ds_read_b64_tr_b16 v[174:175], v47 offset:2912
s_waitcnt lgkmcnt(6)
buffer_store_dwordx4 v[160:163], v19, s[64:67], s15 offen offset:0 sc1
s_waitcnt lgkmcnt(4)
buffer_store_dwordx4 v[164:167], v19, s[64:67], s15 offen offset:1024 sc1
s_waitcnt lgkmcnt(2)
buffer_store_dwordx4 v[168:171], v19, s[64:67], s15 offen offset:2048 sc1
s_waitcnt lgkmcnt(0)
buffer_store_dwordx4 v[172:175], v19, s[64:67], s15 offen offset:3072 sc1
ds_write_b128 v3, v[160:163] offset:8192
ds_write_b128 v3, v[164:167] offset:9216
ds_write_b128 v3, v[168:171] offset:10240
ds_write_b128 v3, v[172:175] offset:11264
s_waitcnt lgkmcnt(0)
s_barrier
ds_read_b128 v[80:83], v4 offset:0
ds_read_b128 v[84:87], v4 offset:1024
ds_read_b128 v[88:91], v4 offset:4096
ds_read_b128 v[92:95], v4 offset:5120
ds_read_b128 v[96:99], v4 offset:8192
ds_read_b128 v[100:103], v4 offset:9216
s_waitcnt lgkmcnt(4)
s_nop 0
v_mfma_f32_32x32x16_bf16 v[48:63], a[160:163], v[80:83], 0
v_mfma_f32_32x32x16_bf16 v[64:79], a[164:167], v[80:83], 0
ds_read_b64_tr_b16 a[180:181], v18
ds_read_b64_tr_b16 a[182:183], v18 offset:1024
ds_write_b128 v8, a[184:187] offset:0
v_mfma_f32_32x32x16_bf16 v[144:159], a[160:163], v[84:87], 0
v_mfma_f32_32x32x16_bf16 v[160:175], a[164:167], v[84:87], 0
ds_write_b128 v8, a[188:191] offset:1024
ds_read_b64_tr_b16 a[184:185], v17
ds_read_b64_tr_b16 a[186:187], v17 offset:1024
s_waitcnt lgkmcnt(8)
s_nop 0
v_mfma_f32_32x32x16_bf16 v[48:63], a[168:171], v[88:91], v[48:63]
v_mfma_f32_32x32x16_bf16 v[64:79], a[172:175], v[88:91], v[64:79]
ds_read_b64_tr_b16 a[188:189], v18
ds_read_b64_tr_b16 a[190:191], v18 offset:1024
ds_write_b128 v8, a[192:195] offset:0
v_mfma_f32_32x32x16_bf16 v[144:159], a[168:171], v[92:95], v[144:159]
v_mfma_f32_32x32x16_bf16 v[160:175], a[172:175], v[92:95], v[160:175]
ds_write_b128 v8, a[196:199] offset:1024
ds_read_b64_tr_b16 a[192:193], v17
ds_read_b64_tr_b16 a[194:195], v17 offset:1024
s_waitcnt lgkmcnt(12)
s_nop 0
v_mfma_f32_32x32x16_bf16 v[48:63], a[48:51], v[96:99], v[48:63]
v_mfma_f32_32x32x16_bf16 v[64:79], a[52:55], v[96:99], v[64:79]
ds_read_b64_tr_b16 a[196:197], v18
ds_read_b64_tr_b16 a[198:199], v18 offset:1024
ds_write_b128 v8, a[200:203] offset:0
v_mfma_f32_32x32x16_bf16 v[144:159], a[48:51], v[100:103], v[144:159]
v_mfma_f32_32x32x16_bf16 v[160:175], a[52:55], v[100:103], v[160:175]
ds_write_b128 v8, a[204:207] offset:1024
ds_read_b64_tr_b16 a[200:201], v17
ds_read_b64_tr_b16 a[202:203], v17 offset:1024
s_waitcnt vmcnt(0)
s_mov_b64 exec, 1
global_store_dword v14, v40, s[44:45] sc1
s_mov_b64 exec, -1
buffer_load_dwordx4 a[140:143], v19, s[76:79], s92 offen offset:1024 sc1
ds_read_b64_tr_b16 a[204:205], v18
ds_read_b64_tr_b16 a[206:207], v18 offset:1024
ds_write_b128 v8, a[208:211] offset:0
s_cmp_ge_u32 s7, 20
s_cselect_b32 s57, 0, 114688
s_add_u32 s57, s57, 1032192
s_add_u32 s28, s57, s25
s_nop 0
buffer_load_dwordx4 a[144:147], v11, s[80:83], s28 offen
ds_write_b128 v8, a[212:215] offset:1024
ds_read_b64_tr_b16 a[208:209], v17
ds_read_b64_tr_b16 a[210:211], v17 offset:1024
buffer_load_dwordx4 a[148:151], v37, s[80:83], s28 offen
ds_read_b64_tr_b16 a[212:213], v18
ds_read_b64_tr_b16 a[214:215], v18 offset:1024
ds_write_b128 v8, a[216:219] offset:0
s_add_u32 s28, s57, s25
s_nop 0
s_add_u32 s28, s28, 28672
buffer_load_dwordx4 a[152:155], v11, s[80:83], s28 offen
ds_write_b128 v8, a[220:223] offset:1024
ds_read_b64_tr_b16 a[216:217], v17
ds_read_b64_tr_b16 a[218:219], v17 offset:1024
buffer_load_dwordx4 a[156:159], v37, s[80:83], s28 offen
ds_read_b64_tr_b16 a[220:221], v18
ds_read_b64_tr_b16 a[222:223], v18 offset:1024
ds_write_b128 v8, a[224:227] offset:0
s_cmp_ge_u32 s7, 20
s_cselect_b32 s27, 0, 2048
s_add_u32 s27, s27, 18432
s_add_u32 s92, s84, s27
buffer_load_dwordx4 v[216:219], v19, s[76:79], s92 offen offset:0 sc1
ds_write_b128 v8, a[228:231] offset:1024
ds_read_b64_tr_b16 a[224:225], v17
ds_read_b64_tr_b16 a[226:227], v17 offset:1024
buffer_load_dwordx4 v[220:223], v19, s[76:79], s92 offen offset:1024 sc1
ds_read_b64_tr_b16 a[228:229], v18
ds_read_b64_tr_b16 a[230:231], v18 offset:1024
ds_write_b128 v8, a[232:235] offset:0
s_cmp_ge_u32 s7, 22
s_cselect_b32 s57, 0, 114688
s_add_u32 s57, s57, 1146880
s_add_u32 s28, s57, s25
buffer_load_dwordx4 v[224:227], v11, s[80:83], s28 offen
ds_write_b128 v8, a[236:239] offset:1024
ds_read_b64_tr_b16 a[232:233], v17
ds_read_b64_tr_b16 a[234:235], v17 offset:1024
buffer_load_dwordx4 v[228:231], v37, s[80:83], s28 offen
ds_read_b64_tr_b16 a[236:237], v18
ds_read_b64_tr_b16 a[238:239], v18 offset:1024
ds_write_b128 v8, a[240:243] offset:0
s_add_u32 s28, s57, s25
s_nop 0
s_add_u32 s28, s28, 28672
buffer_load_dwordx4 v[232:235], v11, s[80:83], s28 offen
ds_write_b128 v8, a[244:247] offset:1024
ds_read_b64_tr_b16 a[240:241], v17
ds_read_b64_tr_b16 a[242:243], v17 offset:1024
buffer_load_dwordx4 v[236:239], v37, s[80:83], s28 offen
ds_read_b64_tr_b16 a[244:245], v18
ds_read_b64_tr_b16 a[246:247], v18 offset:1024
ds_write_b128 v8, a[248:251] offset:0
s_cmp_ge_u32 s7, 22
s_cselect_b32 s27, 0, 2048
s_add_u32 s27, s27, 20480
s_add_u32 s92, s84, s27
buffer_load_dwordx4 v[208:211], v19, s[76:79], s92 offen offset:0 sc1
ds_write_b128 v8, a[252:255] offset:1024
ds_read_b64_tr_b16 a[248:249], v17
ds_read_b64_tr_b16 a[250:251], v17 offset:1024
buffer_load_dwordx4 v[212:215], v19, s[76:79], s92 offen offset:1024 sc1
ds_read_b64_tr_b16 a[252:253], v18
ds_read_b64_tr_b16 a[254:255], v18 offset:1024
ds_write_b128 v8, a[0:3] offset:0
s_cmp_ge_u32 s7, 24
s_cselect_b32 s57, 0, 114688
s_add_u32 s57, s57, 1261568
s_add_u32 s28, s57, s25
buffer_load_dwordx4 v[176:179], v11, s[80:83], s28 offen
ds_write_b128 v8, a[4:7] offset:1024
ds_read_b64_tr_b16 a[0:1], v17
ds_read_b64_tr_b16 a[2:3], v17 offset:1024
buffer_load_dwordx4 v[180:183], v37, s[80:83], s28 offen
ds_read_b64_tr_b16 a[4:5], v18
ds_read_b64_tr_b16 a[6:7], v18 offset:1024
ds_write_b128 v8, a[8:11] offset:0
global_load_dword v42, v16, s[44:45] sc1
s_add_u32 s28, s57, s25
s_nop 0
s_add_u32 s28, s28, 28672
buffer_load_dwordx4 v[184:187], v11, s[80:83], s28 offen
ds_write_b128 v8, a[12:15] offset:1024
ds_read_b64_tr_b16 a[8:9], v17
ds_read_b64_tr_b16 a[10:11], v17 offset:1024
buffer_load_dwordx4 v[188:191], v37, s[80:83], s28 offen
ds_read_b64_tr_b16 a[12:13], v18
ds_read_b64_tr_b16 a[14:15], v18 offset:1024
ds_write_b128 v8, a[16:19] offset:0
s_cmp_ge_u32 s7, 24
s_cselect_b32 s27, 0, 2048
s_add_u32 s27, s27, 22528
s_add_u32 s92, s84, s27
buffer_load_dwordx4 v[192:195], v19, s[76:79], s92 offen offset:0 sc1
ds_write_b128 v8, a[20:23] offset:1024
ds_read_b64_tr_b16 a[16:17], v17
ds_read_b64_tr_b16 a[18:19], v17 offset:1024
buffer_load_dwordx4 v[196:199], v19, s[76:79], s92 offen offset:1024 sc1
ds_read_b64_tr_b16 a[20:21], v18
ds_read_b64_tr_b16 a[22:23], v18 offset:1024
ds_write_b128 v8, a[24:27] offset:0
s_cmp_ge_u32 s7, 26
s_cselect_b32 s57, 0, 114688
s_add_u32 s57, s57, 1376256
s_add_u32 s28, s57, s25
buffer_load_dwordx4 v[200:203], v11, s[80:83], s28 offen
ds_write_b128 v8, a[28:31] offset:1024
ds_read_b64_tr_b16 a[24:25], v17
ds_read_b64_tr_b16 a[26:27], v17 offset:1024
buffer_load_dwordx4 v[204:207], v37, s[80:83], s28 offen
ds_read_b64_tr_b16 a[28:29], v18
ds_read_b64_tr_b16 a[30:31], v18 offset:1024
ds_write_b128 v8, a[32:35] offset:0
s_add_u32 s28, s57, s25
s_nop 0
s_add_u32 s28, s28, 28672
buffer_load_dwordx4 a[160:163], v11, s[80:83], s28 offen
ds_write_b128 v8, a[36:39] offset:1024
ds_read_b64_tr_b16 a[32:33], v17
ds_read_b64_tr_b16 a[34:35], v17 offset:1024
buffer_load_dwordx4 a[164:167], v37, s[80:83], s28 offen
ds_read_b64_tr_b16 a[36:37], v18
ds_read_b64_tr_b16 a[38:39], v18 offset:1024
ds_write_b128 v8, a[40:43] offset:0
s_cmp_ge_u32 s7, 26
s_cselect_b32 s27, 0, 2048
s_add_u32 s27, s27, 24576
s_add_u32 s92, s84, s27
buffer_load_dwordx4 a[168:171], v19, s[76:79], s92 offen offset:0 sc1
ds_write_b128 v8, a[44:47] offset:1024
ds_read_b64_tr_b16 a[40:41], v17
ds_read_b64_tr_b16 a[42:43], v17 offset:1024
buffer_load_dwordx4 a[172:175], v19, s[76:79], s92 offen offset:1024 sc1
ds_read_b64_tr_b16 a[44:45], v18
ds_read_b64_tr_b16 a[46:47], v18 offset:1024
ds_write_b128 v8, a[120:123] offset:0
s_waitcnt vmcnt(10)
v_cmp_eq_u32_e64 vcc, v42, v40
s_nop 0
s_cmp_eq_u64 vcc, -1
s_cbranch_scc0 L_rt_ff
L_bk_ff:
s_cmp_ge_u32 s7, 2
s_cselect_b32 s23, 0, 24576
s_add_u32 s85, s91, s23
buffer_load_dwordx4 v[104:107], v19, s[64:67], s85 offen offset:0 sc1
buffer_load_dwordx4 v[108:111], v19, s[64:67], s85 offen offset:1024 sc1
s_add_u32 s85, s85, 4096
buffer_load_dwordx4 v[112:115], v19, s[64:67], s85 offen offset:0 sc1
buffer_load_dwordx4 v[116:119], v19, s[64:67], s85 offen offset:1024 sc1
s_add_u32 s85, s85, 4096
buffer_load_dwordx4 v[120:123], v19, s[64:67], s85 offen offset:0 sc1
buffer_load_dwordx4 v[124:127], v19, s[64:67], s85 offen offset:1024 sc1
s_cmp_ge_u32 s7, 4
s_cselect_b32 s23, 0, 24576
s_add_u32 s23, s23, 24576
s_add_u32 s85, s91, s23
buffer_load_dwordx4 v[128:131], v19, s[64:67], s85 offen offset:0 sc1
buffer_load_dwordx4 v[132:135], v19, s[64:67], s85 offen offset:1024 sc1
s_add_u32 s85, s85, 4096
buffer_load_dwordx4 v[136:139], v19, s[64:67], s85 offen offset:0 sc1
buffer_load_dwordx4 v[140:143], v19, s[64:67], s85 offen offset:1024 sc1
s_add_u32 s85, s85, 4096
buffer_load_dwordx4 v[80:83], v19, s[64:67], s85 offen offset:0 sc1
buffer_load_dwordx4 v[84:87], v19, s[64:67], s85 offen offset:1024 sc1
s_cmp_ge_u32 s7, 6
s_cselect_b32 s23, 0, 24576
s_add_u32 s23, s23, 49152
s_add_u32 s85, s91, s23
buffer_load_dwordx4 v[88:91], v19, s[64:67], s85 offen offset:0 sc1
buffer_load_dwordx4 v[92:95], v19, s[64:67], s85 offen offset:1024 sc1
v_mul_u32_u24 v10, 272, v36
v_lshl_add_u32 v10, v38, 4, v10
s_mul_i32 s3, s4, 17408
s_add_u32 s3, s3, 69632
v_add_u32 v10, s3, v10
s_lshl_b32 s3, s4, 4
v_add_u32_e64 v11, s3, v5
v_mul_u32_u24 v11, 272, v11
v_lshl_add_u32 v11, v6, 4, v11
v_add_u32 v11, 69632, v11
s_mov_b32 s80, s40
s_mov_b32 s81, s41
s_mov_b32 s82, 0x380000
s_mov_b32 s83, 0x00020000
s_mov_b32 s20, 57344
s_mov_b32 s21, 7168
s_mov_b32 s22, 64512
s_waitcnt vmcnt(12)
s_waitcnt lgkmcnt(15)
v_mfma_f32_32x32x16_bf16 v[48:63], a[176:179], v[104:107], v[48:63]
s_add_u32 s85, s85, 4096
buffer_load_dwordx4 v[96:99], v19, s[64:67], s85 offen offset:0 sc1
v_mfma_f32_32x32x16_bf16 v[64:79], a[180:183], v[104:107], v[64:79]
ds_write_b128 v8, a[124:127] offset:1024
ds_read_b64_tr_b16 a[120:121], v17
ds_read_b64_tr_b16 a[122:123], v17 offset:1024
v_mfma_f32_32x32x16_bf16 v[144:159], a[176:179], v[108:111], v[144:159]
v_mfma_f32_32x32x16_bf16 v[160:175], a[180:183], v[108:111], v[160:175]
ds_read_b64_tr_b16 a[124:125], v18
ds_read_b64_tr_b16 a[126:127], v18 offset:1024
ds_write_b128 v8, a[128:131] offset:0
s_waitcnt vmcnt(11)
s_nop 0
v_mfma_f32_32x32x16_bf16 v[48:63], a[184:187], v[112:115], v[48:63]
buffer_load_dwordx4 v[100:103], v19, s[64:67], s85 offen offset:1024 sc1
v_mfma_f32_32x32x16_bf16 v[64:79], a[188:191], v[112:115], v[64:79]
ds_write_b128 v8, a[132:135] offset:1024
ds_read_b64_tr_b16 a[128:129], v17
ds_read_b64_tr_b16 a[130:131], v17 offset:1024
v_mfma_f32_32x32x16_bf16 v[144:159], a[184:187], v[116:119], v[144:159]
s_add_u32 s85, s85, 4096
buffer_load_dwordx4 v[104:107], v19, s[64:67], s85 offen offset:0 sc1
v_mfma_f32_32x32x16_bf16 v[160:175], a[188:191], v[116:119], v[160:175]
ds_read_b64_tr_b16 a[132:133], v18
ds_read_b64_tr_b16 a[134:135], v18 offset:1024
ds_write_b128 v8, a[144:147] offset:0
s_waitcnt vmcnt(11)
s_nop 0
v_mfma_f32_32x32x16_bf16 v[48:63], a[56:59], v[120:123], v[48:63]
buffer_load_dwordx4 v[108:111], v19, s[64:67], s85 offen offset:1024 sc1
v_mfma_f32_32x32x16_bf16 v[64:79], a[60:63], v[120:123], v[64:79]
ds_write_b128 v8, a[148:151] offset:1024
ds_read_b64_tr_b16 a[144:145], v17
ds_read_b64_tr_b16 a[146:147], v17 offset:1024
v_mfma_f32_32x32x16_bf16 v[144:159], a[56:59], v[124:127], v[144:159]
s_cmp_ge_u32 s7, 8
s_cselect_b32 s23, 0, 24576
s_add_u32 s23, s23, 73728
s_add_u32 s85, s91, s23
buffer_load_dwordx4 v[112:115], v19, s[64:67], s85 offen offset:0 sc1
v_mfma_f32_32x32x16_bf16 v[160:175], a[60:63], v[124:127], v[160:175]
ds_read_b64_tr_b16 a[148:149], v18
ds_read_b64_tr_b16 a[150:151], v18 offset:1024
ds_write_b128 v8, a[152:155] offset:0
s_waitcnt vmcnt(11)
s_nop 0
v_mfma_f32_32x32x16_bf16 v[48:63], a[192:195], v[128:131], v[48:63]
buffer_load_dwordx4 v[116:119], v19, s[64:67], s85 offen offset:1024 sc1
v_mfma_f32_32x32x16_bf16 v[64:79], a[196:199], v[128:131], v[64:79]
ds_write_b128 v8, a[156:159] offset:1024
ds_read_b64_tr_b16 a[152:153], v17
ds_read_b64_tr_b16 a[154:155], v17 offset:1024
v_mfma_f32_32x32x16_bf16 v[144:159], a[192:195], v[132:135], v[144:159]
s_add_u32 s85, s85, 4096
buffer_load_dwordx4 v[120:123], v19, s[64:67], s85 offen offset:0 sc1
v_mfma_f32_32x32x16_bf16 v[160:175], a[196:199], v[132:135], v[160:175]
ds_read_b64_tr_b16 a[156:157], v18
ds_read_b64_tr_b16 a[158:159], v18 offset:1024
ds_write_b128 v8, v[224:227] offset:0
s_waitcnt vmcnt(11)
s_nop 0
v_mfma_f32_32x32x16_bf16 v[48:63], a[200:203], v[136:139], v[48:63]
buffer_load_dwordx4 v[124:127], v19, s[64:67], s85 offen offset:1024 sc1
v_mfma_f32_32x32x16_bf16 v[64:79], a[204:207], v[136:139], v[64:79]
ds_write_b128 v8, v[228:231] offset:1024
ds_read_b64_tr_b16 v[224:225], v17
ds_read_b64_tr_b16 v[226:227], v17 offset:1024
v_mfma_f32_32x32x16_bf16 v[144:159], a[200:203], v[140:143], v[144:159]
s_add_u32 s85, s85, 4096
buffer_load_dwordx4 v[128:131], v19, s[64:67], s85 offen offset:0 sc1
v_mfma_f32_32x32x16_bf16 v[160:175], a[204:207], v[140:143], v[160:175]
ds_read_b64_tr_b16 v[228:229], v18
ds_read_b64_tr_b16 v[230:231], v18 offset:1024
ds_write_b128 v8, v[232:235] offset:0
s_waitcnt vmcnt(11)
s_nop 0
v_mfma_f32_32x32x16_bf16 v[48:63], a[64:67], v[80:83], v[48:63]
buffer_load_dwordx4 v[132:135], v19, s[64:67], s85 offen offset:1024 sc1
v_mfma_f32_32x32x16_bf16 v[64:79], a[68:71], v[80:83], v[64:79]
ds_write_b128 v8, v[236:239] offset:1024
ds_read_b64_tr_b16 v[232:233], v17
ds_read_b64_tr_b16 v[234:235], v17 offset:1024
v_mfma_f32_32x32x16_bf16 v[144:159], a[64:67], v[84:87], v[144:159]
s_cmp_ge_u32 s7, 10
s_cselect_b32 s23, 0, 24576
s_add_u32 s23, s23, 98304
s_add_u32 s85, s91, s23
buffer_load_dwordx4 v[136:139], v19, s[64:67], s85 offen offset:0 sc1
v_mfma_f32_32x32x16_bf16 v[160:175], a[68:71], v[84:87], v[160:175]
ds_read_b64_tr_b16 v[236:237], v18
ds_read_b64_tr_b16 v[238:239], v18 offset:1024
ds_write_b128 v8, v[176:179] offset:0
s_waitcnt vmcnt(11)
s_nop 0
v_mfma_f32_32x32x16_bf16 v[48:63], a[208:211], v[88:91], v[48:63]
buffer_load_dwordx4 v[140:143], v19, s[64:67], s85 offen offset:1024 sc1
v_mfma_f32_32x32x16_bf16 v[64:79], a[212:215], v[88:91], v[64:79]
ds_write_b128 v8, v[180:183] offset:1024
ds_read_b64_tr_b16 v[176:177], v17
ds_read_b64_tr_b16 v[178:179], v17 offset:1024
v_mfma_f32_32x32x16_bf16 v[144:159], a[208:211], v[92:95], v[144:159]
s_add_u32 s85, s85, 4096
buffer_load_dwordx4 v[80:83], v19, s[64:67], s85 offen offset:0 sc1
v_mfma_f32_32x32x16_bf16 v[160:175], a[212:215], v[92:95], v[160:175]
ds_read_b64_tr_b16 v[180:181], v18
ds_read_b64_tr_b16 v[182:183], v18 offset:1024
ds_write_b128 v8, v[184:187] offset:0
s_waitcnt vmcnt(11)
s_nop 0
v_mfma_f32_32x32x16_bf16 v[48:63], a[216:219], v[96:99], v[48:63]
buffer_load_dwordx4 v[84:87], v19, s[64:67], s85 offen offset:1024 sc1
v_mfma_f32_32x32x16_bf16 v[64:79], a[220:223], v[96:99], v[64:79]
ds_write_b128 v8, v[188:191] offset:1024
ds_read_b64_tr_b16 v[184:185], v17
ds_read_b64_tr_b16 v[186:187], v17 offset:1024
v_mfma_f32_32x32x16_bf16 v[144:159], a[216:219], v[100:103], v[144:159]
s_add_u32 s85, s85, 4096
buffer_load_dwordx4 v[88:91], v19, s[64:67], s85 offen offset:0 sc1
v_mfma_f32_32x32x16_bf16 v[160:175], a[220:223], v[100:103], v[160:175]
ds_read_b64_tr_b16 v[188:189], v18
ds_read_b64_tr_b16 v[190:191], v18 offset:1024
ds_write_b128 v8, v[200:203] offset:0
s_waitcnt vmcnt(11)
s_nop 0
v_mfma_f32_32x32x16_bf16 v[48:63], a[72:75], v[104:107], v[48:63]
buffer_load_dwordx4 v[92:95], v19, s[64:67], s85 offen offset:1024 sc1
v_mfma_f32_32x32x16_bf16 v[64:79], a[76:79], v[104:107], v[64:79]
ds_write_b128 v8, v[204:207] offset:1024
ds_read_b64_tr_b16 v[200:201], v17
ds_read_b64_tr_b16 v[202:203], v17 offset:1024
v_mfma_f32_32x32x16_bf16 v[144:159], a[72:75], v[108:111], v[144:159]
s_cmp_ge_u32 s7, 12
s_cselect_b32 s23, 0, 24576
s_add_u32 s23, s23, 122880
s_add_u32 s85, s91, s23
buffer_load_dwordx4 v[96:99], v19, s[64:67], s85 offen offset:0 sc1
v_mfma_f32_32x32x16_bf16 v[160:175], a[76:79], v[108:111], v[160:175]
ds_read_b64_tr_b16 v[204:205], v18
ds_read_b64_tr_b16 v[206:207], v18 offset:1024
ds_write_b128 v8, a[160:163] offset:0
s_waitcnt vmcnt(11)
s_nop 0
v_mfma_f32_32x32x16_bf16 v[48:63], a[224:227], v[112:115], v[48:63]
buffer_load_dwordx4 v[100:103], v19, s[64:67], s85 offen offset:1024 sc1
v_mfma_f32_32x32x16_bf16 v[64:79], a[228:231], v[112:115], v[64:79]
ds_write_b128 v8, a[164:167] offset:1024
ds_read_b64_tr_b16 a[160:161], v17
ds_read_b64_tr_b16 a[162:163], v17 offset:1024
v_mfma_f32_32x32x16_bf16 v[144:159], a[224:227], v[116:119], v[144:159]
s_add_u32 s85, s85, 4096
buffer_load_dwordx4 v[104:107], v19, s[64:67], s85 offen offset:0 sc1
v_mfma_f32_32x32x16_bf16 v[160:175], a[228:231], v[116:119], v[160:175]
ds_read_b64_tr_b16 a[164:165], v18
ds_read_b64_tr_b16 a[166:167], v18 offset:1024
s_waitcnt vmcnt(11)
s_nop 0
v_mfma_f32_32x32x16_bf16 v[48:63], a[232:235], v[120:123], v[48:63]
buffer_load_dwordx4 v[108:111], v19, s[64:67], s85 offen offset:1024 sc1
v_mfma_f32_32x32x16_bf16 v[64:79], a[236:239], v[120:123], v[64:79]
v_mfma_f32_32x32x16_bf16 v[144:159], a[232:235], v[124:127], v[144:159]
s_add_u32 s85, s85, 4096
buffer_load_dwordx4 v[112:115], v19, s[64:67], s85 offen offset:0 sc1
v_mfma_f32_32x32x16_bf16 v[160:175], a[236:239], v[124:127], v[160:175]
s_waitcnt vmcnt(11)
v_mfma_f32_32x32x16_bf16 v[48:63], a[80:83], v[128:131], v[48:63]
buffer_load_dwordx4 v[116:119], v19, s[64:67], s85 offen offset:1024 sc1
v_mfma_f32_32x32x16_bf16 v[64:79], a[84:87], v[128:131], v[64:79]
v_mfma_f32_32x32x16_bf16 v[144:159], a[80:83], v[132:135], v[144:159]
s_cmp_ge_u32 s7, 14
s_cselect_b32 s23, 0, 24576
s_add_u32 s23, s23, 147456
s_add_u32 s85, s91, s23
buffer_load_dwordx4 v[120:123], v19, s[64:67], s85 offen offset:0 sc1
v_mfma_f32_32x32x16_bf16 v[160:175], a[84:87], v[132:135], v[160:175]
s_waitcnt vmcnt(11)
v_mfma_f32_32x32x16_bf16 v[48:63], a[240:243], v[136:139], v[48:63]
buffer_load_dwordx4 v[124:127], v19, s[64:67], s85 offen offset:1024 sc1
v_mfma_f32_32x32x16_bf16 v[64:79], a[244:247], v[136:139], v[64:79]
v_mfma_f32_32x32x16_bf16 v[144:159], a[240:243], v[140:143], v[144:159]
s_add_u32 s85, s85, 4096
buffer_load_dwordx4 v[128:131], v19, s[64:67], s85 offen offset:0 sc1
v_mfma_f32_32x32x16_bf16 v[160:175], a[244:247], v[140:143], v[160:175]
s_waitcnt vmcnt(11)
s_nop 0
v_mfma_f32_32x32x16_bf16 v[48:63], a[248:251], v[80:83], v[48:63]
buffer_load_dwordx4 v[132:135], v19, s[64:67], s85 offen offset:1024 sc1
v_mfma_f32_32x32x16_bf16 v[64:79], a[252:255], v[80:83], v[64:79]
v_mfma_f32_32x32x16_bf16 v[144:159], a[248:251], v[84:87], v[144:159]
s_add_u32 s85, s85, 4096
buffer_load_dwordx4 v[136:139], v19, s[64:67], s85 offen offset:0 sc1
v_mfma_f32_32x32x16_bf16 v[160:175], a[252:255], v[84:87], v[160:175]
s_waitcnt vmcnt(11)
v_mfma_f32_32x32x16_bf16 v[48:63], a[88:91], v[88:91], v[48:63]
buffer_load_dwordx4 v[140:143], v19, s[64:67], s85 offen offset:1024 sc1
v_mfma_f32_32x32x16_bf16 v[64:79], a[92:95], v[88:91], v[64:79]
v_mfma_f32_32x32x16_bf16 v[144:159], a[88:91], v[92:95], v[144:159]
s_cmp_ge_u32 s7, 16
s_cselect_b32 s23, 0, 24576
s_add_u32 s23, s23, 172032
s_add_u32 s85, s91, s23
buffer_load_dwordx4 v[80:83], v19, s[64:67], s85 offen offset:0 sc1
v_mfma_f32_32x32x16_bf16 v[160:175], a[92:95], v[92:95], v[160:175]
s_waitcnt vmcnt(11)
v_mfma_f32_32x32x16_bf16 v[48:63], a[0:3], v[96:99], v[48:63]
buffer_load_dwordx4 v[84:87], v19, s[64:67], s85 offen offset:1024 sc1
v_mfma_f32_32x32x16_bf16 v[64:79], a[4:7], v[96:99], v[64:79]
v_mfma_f32_32x32x16_bf16 v[144:159], a[0:3], v[100:103], v[144:159]
s_add_u32 s85, s85, 4096
buffer_load_dwordx4 v[88:91], v19, s[64:67], s85 offen offset:0 sc1
v_mfma_f32_32x32x16_bf16 v[160:175], a[4:7], v[100:103], v[160:175]
s_waitcnt vmcnt(11)
s_nop 0
v_mfma_f32_32x32x16_bf16 v[48:63], a[8:11], v[104:107], v[48:63]
buffer_load_dwordx4 v[92:95], v19, s[64:67], s85 offen offset:1024 sc1
v_mfma_f32_32x32x16_bf16 v[64:79], a[12:15], v[104:107], v[64:79]
v_mfma_f32_32x32x16_bf16 v[144:159], a[8:11], v[108:111], v[144:159]
s_add_u32 s85, s85, 4096
buffer_load_dwordx4 v[96:99], v19, s[64:67], s85 offen offset:0 sc1
v_mfma_f32_32x32x16_bf16 v[160:175], a[12:15], v[108:111], v[160:175]
s_waitcnt vmcnt(11)
v_mfma_f32_32x32x16_bf16 v[48:63], a[96:99], v[112:115], v[48:63]
buffer_load_dwordx4 v[100:103], v19, s[64:67], s85 offen offset:1024 sc1
v_mfma_f32_32x32x16_bf16 v[64:79], a[100:103], v[112:115], v[64:79]
v_mfma_f32_32x32x16_bf16 v[144:159], a[96:99], v[116:119], v[144:159]
s_cmp_ge_u32 s7, 18
s_cselect_b32 s23, 0, 24576
s_add_u32 s23, s23, 196608
s_add_u32 s85, s91, s23
buffer_load_dwordx4 v[104:107], v19, s[64:67], s85 offen offset:0 sc1
v_mfma_f32_32x32x16_bf16 v[160:175], a[100:103], v[116:119], v[160:175]
s_waitcnt vmcnt(11)
v_mfma_f32_32x32x16_bf16 v[48:63], a[16:19], v[120:123], v[48:63]
buffer_load_dwordx4 v[108:111], v19, s[64:67], s85 offen offset:1024 sc1
v_mfma_f32_32x32x16_bf16 v[64:79], a[20:23], v[120:123], v[64:79]
v_mfma_f32_32x32x16_bf16 v[144:159], a[16:19], v[124:127], v[144:159]
s_add_u32 s85, s85, 4096
buffer_load_dwordx4 v[112:115], v19, s[64:67], s85 offen offset:0 sc1
v_mfma_f32_32x32x16_bf16 v[160:175], a[20:23], v[124:127], v[160:175]
s_waitcnt vmcnt(11)
s_waitcnt lgkmcnt(15)
v_mfma_f32_32x32x16_bf16 v[48:63], a[24:27], v[128:131], v[48:63]
buffer_load_dwordx4 v[116:119], v19, s[64:67], s85 offen offset:1024 sc1
v_mfma_f32_32x32x16_bf16 v[64:79], a[28:31], v[128:131], v[64:79]
v_mfma_f32_32x32x16_bf16 v[144:159], a[24:27], v[132:135], v[144:159]
s_add_u32 s85, s85, 4096
buffer_load_dwordx4 v[120:123], v19, s[64:67], s85 offen offset:0 sc1
v_mfma_f32_32x32x16_bf16 v[160:175], a[28:31], v[132:135], v[160:175]
s_waitcnt vmcnt(11)
v_mfma_f32_32x32x16_bf16 v[48:63], a[104:107], v[136:139], v[48:63]
buffer_load_dwordx4 v[124:127], v19, s[64:67], s85 offen offset:1024 sc1
v_mfma_f32_32x32x16_bf16 v[64:79], a[108:111], v[136:139], v[64:79]
v_mfma_f32_32x32x16_bf16 v[144:159], a[104:107], v[140:143], v[144:159]
s_cmp_ge_u32 s7, 20
s_cselect_b32 s23, 0, 24576
s_add_u32 s23, s23, 221184
s_add_u32 s85, s91, s23
buffer_load_dwordx4 v[128:131], v19, s[64:67], s85 offen offset:0 sc1
v_mfma_f32_32x32x16_bf16 v[160:175], a[108:111], v[140:143], v[160:175]
s_waitcnt vmcnt(11)
v_mfma_f32_32x32x16_bf16 v[48:63], a[32:35], v[80:83], v[48:63]
buffer_load_dwordx4 v[132:135], v19, s[64:67], s85 offen offset:1024 sc1
v_mfma_f32_32x32x16_bf16 v[64:79], a[36:39], v[80:83], v[64:79]
v_mfma_f32_32x32x16_bf16 v[144:159], a[32:35], v[84:87], v[144:159]
s_add_u32 s85, s85, 4096
buffer_load_dwordx4 v[136:139], v19, s[64:67], s85 offen offset:0 sc1
v_mfma_f32_32x32x16_bf16 v[160:175], a[36:39], v[84:87], v[160:175]
s_waitcnt vmcnt(11)
s_nop 0
v_mfma_f32_32x32x16_bf16 v[48:63], a[40:43], v[88:91], v[48:63]
buffer_load_dwordx4 v[140:143], v19, s[64:67], s85 offen offset:1024 sc1
v_mfma_f32_32x32x16_bf16 v[64:79], a[44:47], v[88:91], v[64:79]
v_mfma_f32_32x32x16_bf16 v[144:159], a[40:43], v[92:95], v[144:159]
s_add_u32 s85, s85, 4096
buffer_load_dwordx4 v[80:83], v19, s[64:67], s85 offen offset:0 sc1
v_mfma_f32_32x32x16_bf16 v[160:175], a[44:47], v[92:95], v[160:175]
s_waitcnt vmcnt(11)
v_mfma_f32_32x32x16_bf16 v[48:63], a[112:115], v[96:99], v[48:63]
buffer_load_dwordx4 v[84:87], v19, s[64:67], s85 offen offset:1024 sc1
v_mfma_f32_32x32x16_bf16 v[64:79], a[116:119], v[96:99], v[64:79]
v_mfma_f32_32x32x16_bf16 v[144:159], a[112:115], v[100:103], v[144:159]
s_cmp_ge_u32 s7, 22
s_cselect_b32 s23, 0, 24576
s_add_u32 s23, s23, 245760
s_add_u32 s85, s91, s23
buffer_load_dwordx4 v[88:91], v19, s[64:67], s85 offen offset:0 sc1
v_mfma_f32_32x32x16_bf16 v[160:175], a[116:119], v[100:103], v[160:175]
s_waitcnt vmcnt(11)
v_mfma_f32_32x32x16_bf16 v[48:63], a[120:123], v[104:107], v[48:63]
buffer_load_dwordx4 v[92:95], v19, s[64:67], s85 offen offset:1024 sc1
v_mfma_f32_32x32x16_bf16 v[64:79], a[124:127], v[104:107], v[64:79]
v_mfma_f32_32x32x16_bf16 v[144:159], a[120:123], v[108:111], v[144:159]
s_add_u32 s85, s85, 4096
buffer_load_dwordx4 v[96:99], v19, s[64:67], s85 offen offset:0 sc1
v_mfma_f32_32x32x16_bf16 v[160:175], a[124:127], v[108:111], v[160:175]
s_waitcnt vmcnt(11)
s_nop 0
v_mfma_f32_32x32x16_bf16 v[48:63], a[128:131], v[112:115], v[48:63]
buffer_load_dwordx4 v[100:103], v19, s[64:67], s85 offen offset:1024 sc1
v_mfma_f32_32x32x16_bf16 v[64:79], a[132:135], v[112:115], v[64:79]
v_mfma_f32_32x32x16_bf16 v[144:159], a[128:131], v[116:119], v[144:159]
s_add_u32 s85, s85, 4096
buffer_load_dwordx4 v[104:107], v19, s[64:67], s85 offen offset:0 sc1
v_mfma_f32_32x32x16_bf16 v[160:175], a[132:135], v[116:119], v[160:175]
s_waitcnt vmcnt(11)
v_mfma_f32_32x32x16_bf16 v[48:63], a[136:139], v[120:123], v[48:63]
buffer_load_dwordx4 v[108:111], v19, s[64:67], s85 offen offset:1024 sc1
v_mfma_f32_32x32x16_bf16 v[64:79], a[140:143], v[120:123], v[64:79]
v_mfma_f32_32x32x16_bf16 v[144:159], a[136:139], v[124:127], v[144:159]
s_cmp_ge_u32 s7, 24
s_cselect_b32 s23, 0, 24576
s_add_u32 s23, s23, 270336
s_add_u32 s85, s91, s23
buffer_load_dwordx4 v[112:115], v19, s[64:67], s85 offen offset:0 sc1
v_mfma_f32_32x32x16_bf16 v[160:175], a[140:143], v[124:127], v[160:175]
s_waitcnt vmcnt(11)
v_mfma_f32_32x32x16_bf16 v[48:63], a[144:147], v[128:131], v[48:63]
buffer_load_dwordx4 v[116:119], v19, s[64:67], s85 offen offset:1024 sc1
v_mfma_f32_32x32x16_bf16 v[64:79], a[148:151], v[128:131], v[64:79]
v_mfma_f32_32x32x16_bf16 v[144:159], a[144:147], v[132:135], v[144:159]
s_add_u32 s85, s85, 4096
buffer_load_dwordx4 v[120:123], v19, s[64:67], s85 offen offset:0 sc1
v_mfma_f32_32x32x16_bf16 v[160:175], a[148:151], v[132:135], v[160:175]
s_waitcnt vmcnt(11)
s_nop 0
v_mfma_f32_32x32x16_bf16 v[48:63], a[152:155], v[136:139], v[48:63]
buffer_load_dwordx4 v[124:127], v19, s[64:67], s85 offen offset:1024 sc1
v_mfma_f32_32x32x16_bf16 v[64:79], a[156:159], v[136:139], v[64:79]
v_mfma_f32_32x32x16_bf16 v[144:159], a[152:155], v[140:143], v[144:159]
s_add_u32 s85, s85, 4096
buffer_load_dwordx4 v[128:131], v19, s[64:67], s85 offen offset:0 sc1
v_mfma_f32_32x32x16_bf16 v[160:175], a[156:159], v[140:143], v[160:175]
s_waitcnt vmcnt(11)
v_mfma_f32_32x32x16_bf16 v[48:63], v[216:219], v[80:83], v[48:63]
buffer_load_dwordx4 v[132:135], v19, s[64:67], s85 offen offset:1024 sc1
v_mfma_f32_32x32x16_bf16 v[64:79], v[220:223], v[80:83], v[64:79]
v_mfma_f32_32x32x16_bf16 v[144:159], v[216:219], v[84:87], v[144:159]
s_cmp_ge_u32 s7, 26
s_cselect_b32 s23, 0, 24576
s_add_u32 s23, s23, 294912
s_add_u32 s85, s91, s23
buffer_load_dwordx4 v[136:139], v19, s[64:67], s85 offen offset:0 sc1
v_mfma_f32_32x32x16_bf16 v[160:175], v[220:223], v[84:87], v[160:175]
s_waitcnt vmcnt(11)
v_mfma_f32_32x32x16_bf16 v[48:63], v[224:227], v[88:91], v[48:63]
buffer_load_dwordx4 v[140:143], v19, s[64:67], s85 offen offset:1024 sc1
v_mfma_f32_32x32x16_bf16 v[64:79], v[228:231], v[88:91], v[64:79]
v_mfma_f32_32x32x16_bf16 v[144:159], v[224:227], v[92:95], v[144:159]
s_add_u32 s85, s85, 4096
buffer_load_dwordx4 v[80:83], v19, s[64:67], s85 offen offset:0 sc1
v_mfma_f32_32x32x16_bf16 v[160:175], v[228:231], v[92:95], v[160:175]
s_waitcnt vmcnt(11)
s_nop 0
v_mfma_f32_32x32x16_bf16 v[48:63], v[232:235], v[96:99], v[48:63]
buffer_load_dwordx4 v[84:87], v19, s[64:67], s85 offen offset:1024 sc1
v_mfma_f32_32x32x16_bf16 v[64:79], v[236:239], v[96:99], v[64:79]
v_mfma_f32_32x32x16_bf16 v[144:159], v[232:235], v[100:103], v[144:159]
s_add_u32 s85, s85, 4096
buffer_load_dwordx4 v[88:91], v19, s[64:67], s85 offen offset:0 sc1
v_mfma_f32_32x32x16_bf16 v[160:175], v[236:239], v[100:103], v[160:175]
s_waitcnt vmcnt(11)
v_mfma_f32_32x32x16_bf16 v[48:63], v[208:211], v[104:107], v[48:63]
buffer_load_dwordx4 v[92:95], v19, s[64:67], s85 offen offset:1024 sc1
v_mfma_f32_32x32x16_bf16 v[64:79], v[212:215], v[104:107], v[64:79]
v_mfma_f32_32x32x16_bf16 v[144:159], v[208:211], v[108:111], v[144:159]
v_mfma_f32_32x32x16_bf16 v[160:175], v[212:215], v[108:111], v[160:175]
s_waitcnt vmcnt(10)
v_mfma_f32_32x32x16_bf16 v[48:63], v[176:179], v[112:115], v[48:63]
v_mfma_f32_32x32x16_bf16 v[64:79], v[180:183], v[112:115], v[64:79]
v_mfma_f32_32x32x16_bf16 v[144:159], v[176:179], v[116:119], v[144:159]
v_mfma_f32_32x32x16_bf16 v[160:175], v[180:183], v[116:119], v[160:175]
s_waitcnt vmcnt(8)
s_waitcnt lgkmcnt(12)
v_mfma_f32_32x32x16_bf16 v[48:63], v[184:187], v[120:123], v[48:63]
v_mfma_f32_32x32x16_bf16 v[64:79], v[188:191], v[120:123], v[64:79]
v_mfma_f32_32x32x16_bf16 v[144:159], v[184:187], v[124:127], v[144:159]
v_mfma_f32_32x32x16_bf16 v[160:175], v[188:191], v[124:127], v[160:175]
s_waitcnt vmcnt(6)
v_mfma_f32_32x32x16_bf16 v[48:63], v[192:195], v[128:131], v[48:63]
v_mfma_f32_32x32x16_bf16 v[64:79], v[196:199], v[128:131], v[64:79]
v_mfma_f32_32x32x16_bf16 v[144:159], v[192:195], v[132:135], v[144:159]
v_mfma_f32_32x32x16_bf16 v[160:175], v[196:199], v[132:135], v[160:175]
s_waitcnt vmcnt(4)
s_waitcnt lgkmcnt(6)
v_mfma_f32_32x32x16_bf16 v[48:63], v[200:203], v[136:139], v[48:63]
v_mfma_f32_32x32x16_bf16 v[64:79], v[204:207], v[136:139], v[64:79]
v_mfma_f32_32x32x16_bf16 v[144:159], v[200:203], v[140:143], v[144:159]
v_mfma_f32_32x32x16_bf16 v[160:175], v[204:207], v[140:143], v[160:175]
s_waitcnt vmcnt(2)
s_waitcnt lgkmcnt(0)
v_mfma_f32_32x32x16_bf16 v[48:63], a[160:163], v[80:83], v[48:63]
v_mfma_f32_32x32x16_bf16 v[64:79], a[164:167], v[80:83], v[64:79]
v_mfma_f32_32x32x16_bf16 v[144:159], a[160:163], v[84:87], v[144:159]
v_mfma_f32_32x32x16_bf16 v[160:175], a[164:167], v[84:87], v[160:175]
s_waitcnt vmcnt(0)
v_mfma_f32_32x32x16_bf16 v[48:63], a[168:171], v[88:91], v[48:63]
v_mfma_f32_32x32x16_bf16 v[64:79], a[172:175], v[88:91], v[64:79]
v_mfma_f32_32x32x16_bf16 v[144:159], a[168:171], v[92:95], v[144:159]
v_mfma_f32_32x32x16_bf16 v[160:175], a[172:175], v[92:95], v[160:175]
s_nop 8
s_nop 0
ds_write_b128 v10, v[48:51] offset:0
ds_write_b128 v10, v[52:55] offset:32
ds_write_b128 v10, v[56:59] offset:64
ds_write_b128 v10, v[60:63] offset:96
ds_write_b128 v10, v[64:67] offset:128
ds_write_b128 v10, v[68:71] offset:160
ds_write_b128 v10, v[72:75] offset:192
ds_write_b128 v10, v[76:79] offset:224
ds_write_b128 v10, v[144:147] offset:8704
ds_write_b128 v10, v[148:151] offset:8736
ds_write_b128 v10, v[152:155] offset:8768
ds_write_b128 v10, v[156:159] offset:8800
ds_write_b128 v10, v[160:163] offset:8832
ds_write_b128 v10, v[164:167] offset:8864
ds_write_b128 v10, v[168:171] offset:8896
ds_write_b128 v10, v[172:175] offset:8928
s_waitcnt lgkmcnt(0)
s_barrier
ds_read_b128 v[80:83], v11 offset:0
ds_read_b128 v[84:87], v11 offset:17408
ds_read_b128 v[88:91], v11 offset:34816
ds_read_b128 v[92:95], v11 offset:52224
ds_read_b128 v[96:99], v11 offset:1088
ds_read_b128 v[100:103], v11 offset:18496
ds_read_b128 v[104:107], v11 offset:35904
ds_read_b128 v[108:111], v11 offset:53312
ds_read_b128 v[112:115], v11 offset:2176
ds_read_b128 v[116:119], v11 offset:19584
ds_read_b128 v[120:123], v11 offset:36992
ds_read_b128 v[124:127], v11 offset:54400
ds_read_b128 v[128:131], v11 offset:3264
ds_read_b128 v[132:135], v11 offset:20672
ds_read_b128 v[136:139], v11 offset:38080
ds_read_b128 v[140:143], v11 offset:55488
s_waitcnt lgkmcnt(15)
v_pk_add_f32 v[240:241], v[240:241], v[80:81]
v_pk_add_f32 v[242:243], v[242:243], v[82:83]
s_waitcnt lgkmcnt(14)
v_pk_add_f32 v[240:241], v[240:241], v[84:85]
v_pk_add_f32 v[242:243], v[242:243], v[86:87]
s_waitcnt lgkmcnt(13)
v_pk_add_f32 v[240:241], v[240:241], v[88:89]
v_pk_add_f32 v[242:243], v[242:243], v[90:91]
s_waitcnt lgkmcnt(12)
v_pk_add_f32 v[240:241], v[240:241], v[92:93]
v_pk_add_f32 v[242:243], v[242:243], v[94:95]
buffer_store_dwordx4 v[240:243], v9, s[80:83], 0 offen sc1
s_waitcnt lgkmcnt(11)
v_pk_add_f32 v[244:245], v[244:245], v[96:97]
v_pk_add_f32 v[246:247], v[246:247], v[98:99]
s_waitcnt lgkmcnt(10)
v_pk_add_f32 v[244:245], v[244:245], v[100:101]
v_pk_add_f32 v[246:247], v[246:247], v[102:103]
s_waitcnt lgkmcnt(9)
v_pk_add_f32 v[244:245], v[244:245], v[104:105]
v_pk_add_f32 v[246:247], v[246:247], v[106:107]
s_waitcnt lgkmcnt(8)
v_pk_add_f32 v[244:245], v[244:245], v[108:109]
v_pk_add_f32 v[246:247], v[246:247], v[110:111]
buffer_store_dwordx4 v[244:247], v9, s[80:83], s20 offen sc1
s_waitcnt lgkmcnt(7)
v_pk_add_f32 v[248:249], v[248:249], v[112:113]
v_pk_add_f32 v[250:251], v[250:251], v[114:115]
s_waitcnt lgkmcnt(6)
v_pk_add_f32 v[248:249], v[248:249], v[116:117]
v_pk_add_f32 v[250:251], v[250:251], v[118:119]
s_waitcnt lgkmcnt(5)
v_pk_add_f32 v[248:249], v[248:249], v[120:121]
v_pk_add_f32 v[250:251], v[250:251], v[122:123]
s_waitcnt lgkmcnt(4)
v_pk_add_f32 v[248:249], v[248:249], v[124:125]
v_pk_add_f32 v[250:251], v[250:251], v[126:127]
buffer_store_dwordx4 v[248:251], v9, s[80:83], s21 offen sc1
s_waitcnt lgkmcnt(3)
v_pk_add_f32 v[252:253], v[252:253], v[128:129]
v_pk_add_f32 v[254:255], v[254:255], v[130:131]
s_waitcnt lgkmcnt(2)
v_pk_add_f32 v[252:253], v[252:253], v[132:133]
v_pk_add_f32 v[254:255], v[254:255], v[134:135]
s_waitcnt lgkmcnt(1)
v_pk_add_f32 v[252:253], v[252:253], v[136:137]
v_pk_add_f32 v[254:255], v[254:255], v[138:139]
s_waitcnt lgkmcnt(0)
v_pk_add_f32 v[252:253], v[252:253], v[140:141]
v_pk_add_f32 v[254:255], v[254:255], v[142:143]
buffer_store_dwordx4 v[252:255], v9, s[80:83], s22 offen sc1
s_lshl_b32 s3, s7, 5
s_add_u32 s3, s3, s93
s_cmp_lg_u32 s3, 95
s_cbranch_scc1 L_fin
v_mov_b32 v1, s10
v_mov_b32 v3, 0
global_store_dword v3, v1, s[70:71] sc1
L_fin:
s_endpgm
L_rt_cs:
s_mov_b32 s14, 0
L_rl_cs:
s_sleep 2
global_load_dwordx2 v[224:225], v32, s[44:45] sc1
s_waitcnt vmcnt(0)
v_cmp_eq_u32 vcc, v225, v40
s_nop 0
s_cmp_eq_u64 vcc, -1
s_cbranch_scc1 L_bk_cs
s_add_u32 s14, s14, 1
s_cmp_lt_u32 s14, 0x20000
s_cbranch_scc1 L_rl_cs
s_branch L_bk_cs
L_rt_cw:
s_mov_b32 s14, 0
L_rl_cw:
s_sleep 2
global_load_dwordx2 v[236:237], v5, s[44:45] sc1
global_load_dwordx2 v[238:239], v5, s[44:45] offset:256 sc1
s_waitcnt vmcnt(0)
v_xor_b32 v1, v237, v40
v_xor_b32 v41, v239, v40
v_or_b32 v1, v1, v41
v_cmp_eq_u32 vcc, 0, v1
s_nop 0
s_cmp_eq_u64 vcc, -1
s_cbranch_scc1 L_bk_cw
s_add_u32 s14, s14, 1
s_cmp_lt_u32 s14, 0x20000
s_cbranch_scc1 L_rl_cw
s_branch L_bk_cw
L_rt_bt:
s_mov_b32 s14, 0
L_rl_bt:
s_sleep 2
global_load_dword v33, v12, s[44:45] sc1
s_waitcnt vmcnt(0)
v_cmp_eq_u32_e64 vcc, v33, v40
s_nop 0
s_cmp_eq_u64 vcc, -1
s_cbranch_scc1 L_bk_bt
s_add_u32 s14, s14, 1
s_cmp_lt_u32 s14, 0x20000
s_cbranch_scc1 L_rl_bt
s_branch L_bk_bt
L_rt_lb:
s_mov_b32 s14, 0
L_rl_lb:
s_sleep 2
buffer_load_dwordx4 v[176:179], v208, s[72:75], 0 offen sc1
buffer_load_dwordx4 v[180:183], v209, s[72:75], 0 offen sc1
buffer_load_dwordx4 v[184:187], v210, s[72:75], 0 offen sc1
buffer_load_dwordx4 v[188:191], v211, s[72:75], 0 offen sc1
buffer_load_dwordx4 v[192:195], v212, s[72:75], 0 offen sc1
buffer_load_dwordx4 v[196:199], v213, s[72:75], 0 offen sc1
buffer_load_dwordx4 v[200:203], v214, s[72:75], 0 offen sc1
buffer_load_dwordx4 v[204:207], v215, s[72:75], 0 offen sc1
s_waitcnt vmcnt(0)
s_nop 0
v_add3_u32 v152, v177, v179, v181
v_add3_u32 v153, v183, v185, v187
v_add3_u32 v152, v152, v189, v191
v_add3_u32 v153, v153, v193, v195
v_add3_u32 v152, v152, v197, v199
v_add3_u32 v153, v153, v201, v203
v_add3_u32 v152, v152, v205, v207
v_add_u32 v152, v152, v153
v_cmp_eq_u32 vcc, v152, v154
s_nop 0
s_cmp_eq_u64 vcc, -1
s_cbranch_scc1 L_bk_lb
s_add_u32 s14, s14, 1
s_cmp_lt_u32 s14, 0x20000
s_cbranch_scc1 L_rl_lb
s_branch L_bk_lb
L_rt_ff:
s_mov_b32 s14, 0
L_rl_ff:
s_sleep 2
global_load_dword v42, v16, s[44:45] sc1
s_waitcnt vmcnt(0)
v_cmp_eq_u32 vcc, v42, v40
s_nop 0
s_cmp_eq_u64 vcc, -1
s_cbranch_scc1 L_bk_ff
s_add_u32 s14, s14, 1
s_cmp_lt_u32 s14, 0x20000
s_cbranch_scc1 L_rl_ff
s_branch L_bk_ff
L_pretile:
s_sub_u32 s11, s11, 28
s_lshl_b32 s12, s12, 2
s_add_u32 s11, s11, s12
s_lshl_b32 s3, s4, 5
s_add_u32 s3, s3, s11
s_mov_b32 s65, s3
s_min_u32 s3, s3, 97
s_mov_b32 s66, s11
s_lshl_b32 s67, s11, 2
s_add_u32 s67, s67, s4
s_and_b32 s14, s3, 1
s_lshr_b32 s3, s3, 1
s_mul_i32 s11, s3, 37
s_lshr_b32 s11, s11, 8
s_mul_i32 s12, s11, 7
s_sub_u32 s12, s3, s12
s_mul_i32 s6, s4, 9216
v_lshrrev_b32 v34, 3, v0
v_and_b32 v35, 7, v0
v_lshrrev_b32 v38, 5, v0
v_and_b32 v36, 31, v0
v_mul_u32_u24 v2, 896, v34
v_lshrrev_b32 v1, 1, v34
v_xor_b32 v1, v1, v35
v_xor_b32 v3, 4, v1
v_lshl_add_u32 v1, v1, 4, v2
v_lshl_add_u32 v3, v3, 4, v2
v_add_u32 v9, 0, v1
v_add_u32 v10, 6144, v3
v_add_u32 v11, 12288, v1
v_add_u32 v12, 18432, v3
s_lshl_b32 s3, s11, 1
s_add_u32 s3, s3, s14
s_mul_i32 s13, s3, 28672
s_lshl_b32 s3, s12, 7
s_add_u32 s13, s13, s3
v_lshlrev_b32 v37, 1, v0
v_add_u32_e64 v37, s3, v37
v_lshl_add_u32 v4, v35, 4, v2
v_mul_u32_u24 v5, 3584, v34
v_lshl_add_u32 v5, v35, 4, v5
s_mov_b32 s88, 0x3f803f80
s_mov_b32 s89, 0x3f80
s_mov_b32 s90, 0x3f800000
s_sub_u32 s68, s67, 56
s_cmp_ge_u32 s67, 56
s_cselect_b32 s68, s68, s67
s_mul_i32 s68, s68, 7168
s_mul_i32 s69, s4, 401408
s_lshl_b32 s3, s66, 7
s_add_u32 s69, s69, s3
s_mov_b32 s62, 0x62000
s_mov_b32 s63, 0x00020000
s_cmp_ge_u32 s67, 56
s_waitcnt lgkmcnt(0)
s_cselect_b32 s60, s24, s22
s_cselect_b32 s61, s25, s23
buffer_load_dwordx4 v[176:179], v4, s[60:63], s68 offen offset:0
buffer_load_dwordx4 v[180:183], v4, s[60:63], s68 offen offset:128
buffer_load_dwordx4 v[184:187], v4, s[60:63], s68 offen offset:256
buffer_load_dwordx4 v[188:191], v4, s[60:63], s68 offen offset:384
buffer_load_dwordx4 v[192:195], v4, s[60:63], s68 offen offset:512
buffer_load_dwordx4 v[196:199], v4, s[60:63], s68 offen offset:640
buffer_load_dwordx4 v[200:203], v4, s[60:63], s68 offen offset:768
s_add_u32 s70, s44, 0xe80000
s_addc_u32 s71, s45, 0
s_load_dword s10, s[70:71], 0
s_mov_b32 s48, s36
s_mov_b32 s49, s37
s_nop 0
s_mov_b32 s50, 0x188000
s_mov_b32 s51, 0x00020000
buffer_load_dwordx4 v[48:51], v5, s[48:51], s69 offen
s_add_u32 s69, s69, 28672
buffer_load_dwordx4 v[52:55], v5, s[48:51], s69 offen
s_add_u32 s69, s69, 28672
buffer_load_dwordx4 v[56:59], v5, s[48:51], s69 offen
s_add_u32 s69, s69, 28672
buffer_load_dwordx4 v[60:63], v5, s[48:51], s69 offen
s_add_u32 s69, s69, 28672
buffer_load_dwordx4 v[64:67], v5, s[48:51], s69 offen
s_add_u32 s69, s69, 28672
buffer_load_dwordx4 v[68:71], v5, s[48:51], s69 offen
s_add_u32 s69, s69, 28672
buffer_load_dwordx4 v[72:75], v5, s[48:51], s69 offen
s_add_u32 s69, s69, 28672
buffer_load_dwordx4 v[76:79], v5, s[48:51], s69 offen
s_add_u32 s69, s69, 28672
buffer_load_dwordx4 v[80:83], v5, s[48:51], s69 offen
s_add_u32 s69, s69, 28672
buffer_load_dwordx4 v[84:87], v5, s[48:51], s69 offen
s_add_u32 s69, s69, 28672
buffer_load_dwordx4 v[88:91], v5, s[48:51], s69 offen
s_add_u32 s69, s69, 28672
buffer_load_dwordx4 v[92:95], v5, s[48:51], s69 offen
s_add_u32 s69, s69, 28672
buffer_load_dwordx4 v[96:99], v5, s[48:51], s69 offen
s_add_u32 s69, s69, 28672
buffer_load_dwordx4 v[100:103], v5, s[48:51], s69 offen
s_add_u32 s69, s69, 28672
s_add_u32 s76, s44, 0xb00000
s_addc_u32 s77, s45, 0
s_mov_b32 s78, 0x24c000
s_mov_b32 s79, 0x00020000
v_bfe_u32 v1, v0, 1, 3
v_lshlrev_b32 v1, 4, v1
v_lshl_add_u32 v1, v36, 7, v1
v_lshl_add_u32 v1, v38, 3, v1
v_add_u32 v20, s6, v1
v_lshlrev_b32 v19, 4, v0
v_lshlrev_b32 v21, 3, v0
v_add_u32 v21, s6, v21
v_lshlrev_b32 v22, 5, v38
v_add_u32 v22, s6, v22
v_xor_b32 v160, 0, v20
v_xor_b32 v161, 16, v20
v_xor_b32 v162, 32, v20
v_xor_b32 v163, 48, v20
v_xor_b32 v164, 64, v20
v_xor_b32 v165, 80, v20
v_xor_b32 v166, 96, v20
v_xor_b32 v167, 112, v20
s_lshl_b32 s64, s11, 4
s_lshl_b32 s3, s12, 1
s_add_u32 s64, s64, s3
s_add_u32 s64, s64, s14
s_lshl_b32 s64, s64, 8
s_add_u32 s64, s64, 0x1080000
v_mov_b32 v220, s64
s_mul_i32 s11, s11, 114688
s_lshl_b32 s3, s12, 12
s_add_u32 s11, s11, s3
s_lshl_b32 s3, s14, 10
s_add_u32 s11, s11, s3
s_waitcnt lgkmcnt(0)
s_add_u32 s10, s10, 2
s_or_b32 s9, s10, 1
v_mov_b32 v40, s9
s_waitcnt vmcnt(14)
v_dot2_f32_bf16 v28, v176, s88, 0
v_dot2_f32_bf16 v29, v177, s88, 0
v_dot2_f32_bf16 v28, v178, s88, v28
v_dot2_f32_bf16 v29, v179, s88, v29
v_dot2_f32_bf16 v28, v180, s88, v28
v_dot2_f32_bf16 v29, v181, s88, v29
v_dot2_f32_bf16 v28, v182, s88, v28
v_dot2_f32_bf16 v29, v183, s88, v29
v_dot2_f32_bf16 v28, v184, s88, v28
v_dot2_f32_bf16 v29, v185, s88, v29
v_dot2_f32_bf16 v28, v186, s88, v28
v_dot2_f32_bf16 v29, v187, s88, v29
v_dot2_f32_bf16 v28, v188, s88, v28
v_dot2_f32_bf16 v29, v189, s88, v29
v_dot2_f32_bf16 v28, v190, s88, v28
v_dot2_f32_bf16 v29, v191, s88, v29
v_dot2_f32_bf16 v28, v192, s88, v28
v_dot2_f32_bf16 v29, v193, s88, v29
v_dot2_f32_bf16 v28, v194, s88, v28
v_dot2_f32_bf16 v29, v195, s88, v29
v_dot2_f32_bf16 v28, v196, s88, v28
v_dot2_f32_bf16 v29, v197, s88, v29
v_dot2_f32_bf16 v28, v198, s88, v28
v_dot2_f32_bf16 v29, v199, s88, v29
v_dot2_f32_bf16 v28, v200, s88, v28
v_dot2_f32_bf16 v29, v201, s88, v29
v_dot2_f32_bf16 v28, v202, s88, v28
v_dot2_f32_bf16 v29, v203, s88, v29
s_nop 2
v_add_f32 v28, v28, v29
s_nop 1
v_add_f32_dpp v28, v28, v28 quad_perm:[1,0,3,2] row_mask:0xf bank_mask:0xf
s_nop 1
v_add_f32_dpp v28, v28, v28 quad_perm:[2,3,0,1] row_mask:0xf bank_mask:0xf
s_nop 1
v_add_f32_dpp v28, v28, v28 row_half_mirror row_mask:0xf bank_mask:0xf
v_mov_b32_e64 v29, v40
s_lshl_b32 s3, s67, 7
s_add_u32 s3, s3, 0x1110000
v_lshl_add_u32 v4, v34, 3, s3
s_cmp_ge_u32 s67, 112
s_cbranch_scc1 L_pt_nob
global_store_dwordx2 v4, v[28:29], s[44:45] sc1
L_pt_nob:
s_waitcnt vmcnt(13)
v_dot2_f32_bf16 v208, v48, s89, 0
v_dot2_f32_bf16 v209, v48, s90, 0
v_dot2_f32_bf16 v210, v49, s89, 0
v_dot2_f32_bf16 v211, v49, s90, 0
v_dot2_f32_bf16 v212, v50, s89, 0
v_dot2_f32_bf16 v213, v50, s90, 0
v_dot2_f32_bf16 v214, v51, s89, 0
v_dot2_f32_bf16 v215, v51, s90, 0
s_waitcnt vmcnt(12)
s_nop 0
v_dot2_f32_bf16 v208, v52, s89, v208
v_dot2_f32_bf16 v209, v52, s90, v209
v_dot2_f32_bf16 v210, v53, s89, v210
v_dot2_f32_bf16 v211, v53, s90, v211
v_dot2_f32_bf16 v212, v54, s89, v212
v_dot2_f32_bf16 v213, v54, s90, v213
v_dot2_f32_bf16 v214, v55, s89, v214
v_dot2_f32_bf16 v215, v55, s90, v215
s_waitcnt vmcnt(11)
s_nop 0
v_dot2_f32_bf16 v208, v56, s89, v208
v_dot2_f32_bf16 v209, v56, s90, v209
v_dot2_f32_bf16 v210, v57, s89, v210
v_dot2_f32_bf16 v211, v57, s90, v211
v_dot2_f32_bf16 v212, v58, s89, v212
v_dot2_f32_bf16 v213, v58, s90, v213
v_dot2_f32_bf16 v214, v59, s89, v214
v_dot2_f32_bf16 v215, v59, s90, v215
s_waitcnt vmcnt(10)
s_nop 0
v_dot2_f32_bf16 v208, v60, s89, v208
v_dot2_f32_bf16 v209, v60, s90, v209
v_dot2_f32_bf16 v210, v61, s89, v210
v_dot2_f32_bf16 v211, v61, s90, v211
v_dot2_f32_bf16 v212, v62, s89, v212
v_dot2_f32_bf16 v213, v62, s90, v213
v_dot2_f32_bf16 v214, v63, s89, v214
v_dot2_f32_bf16 v215, v63, s90, v215
s_waitcnt vmcnt(9)
s_nop 0
v_dot2_f32_bf16 v208, v64, s89, v208
v_dot2_f32_bf16 v209, v64, s90, v209
v_dot2_f32_bf16 v210, v65, s89, v210
v_dot2_f32_bf16 v211, v65, s90, v211
v_dot2_f32_bf16 v212, v66, s89, v212
v_dot2_f32_bf16 v213, v66, s90, v213
v_dot2_f32_bf16 v214, v67, s89, v214
v_dot2_f32_bf16 v215, v67, s90, v215
s_waitcnt vmcnt(8)
s_nop 0
v_dot2_f32_bf16 v208, v68, s89, v208
v_dot2_f32_bf16 v209, v68, s90, v209
v_dot2_f32_bf16 v210, v69, s89, v210
v_dot2_f32_bf16 v211, v69, s90, v211
v_dot2_f32_bf16 v212, v70, s89, v212
v_dot2_f32_bf16 v213, v70, s90, v213
v_dot2_f32_bf16 v214, v71, s89, v214
v_dot2_f32_bf16 v215, v71, s90, v215
s_waitcnt vmcnt(7)
s_nop 0
v_dot2_f32_bf16 v208, v72, s89, v208
v_dot2_f32_bf16 v209, v72, s90, v209
v_dot2_f32_bf16 v210, v73, s89, v210
v_dot2_f32_bf16 v211, v73, s90, v211
v_dot2_f32_bf16 v212, v74, s89, v212
v_dot2_f32_bf16 v213, v74, s90, v213
v_dot2_f32_bf16 v214, v75, s89, v214
v_dot2_f32_bf16 v215, v75, s90, v215
s_waitcnt vmcnt(6)
s_nop 0
v_dot2_f32_bf16 v208, v76, s89, v208
v_dot2_f32_bf16 v209, v76, s90, v209
v_dot2_f32_bf16 v210, v77, s89, v210
v_dot2_f32_bf16 v211, v77, s90, v211
v_dot2_f32_bf16 v212, v78, s89, v212
v_dot2_f32_bf16 v213, v78, s90, v213
v_dot2_f32_bf16 v214, v79, s89, v214
v_dot2_f32_bf16 v215, v79, s90, v215
s_mov_b32 s52, s26
s_mov_b32 s53, s27
s_mov_b32 s54, 0x62000
s_mov_b32 s55, 0x00020000
s_mov_b32 s56, s28
s_mov_b32 s57, s29
s_mov_b32 s58, 0x62000
s_mov_b32 s59, 0x00020000
global_load_ushort v24, v37, s[18:19]
global_load_ushort v25, v37, s[20:21]
global_load_ushort v26, v37, s[30:31]
s_add_u32 m0, s6, 0
s_nop 0
buffer_load_dwordx4 v9, s[52:55], s13 offen offset:0 lds
buffer_load_dwordx4 v10, s[52:55], s13 offen offset:1024 lds
buffer_load_dwordx4 v11, s[52:55], s13 offen offset:2048 lds
buffer_load_dwordx4 v12, s[52:55], s13 offen offset:3072 lds
s_add_u32 m0, s6, 4096
s_nop 0
buffer_load_dwordx4 v9, s[56:59], s13 offen offset:0 lds
buffer_load_dwordx4 v10, s[56:59], s13 offen offset:1024 lds
buffer_load_dwordx4 v11, s[56:59], s13 offen offset:2048 lds
buffer_load_dwordx4 v12, s[56:59], s13 offen offset:3072 lds
s_waitcnt vmcnt(16)
v_dot2_f32_bf16 v208, v80, s89, v208
v_dot2_f32_bf16 v209, v80, s90, v209
v_dot2_f32_bf16 v210, v81, s89, v210
v_dot2_f32_bf16 v211, v81, s90, v211
v_dot2_f32_bf16 v212, v82, s89, v212
v_dot2_f32_bf16 v213, v82, s90, v213
v_dot2_f32_bf16 v214, v83, s89, v214
v_dot2_f32_bf16 v215, v83, s90, v215
s_waitcnt vmcnt(15)
s_nop 0
v_dot2_f32_bf16 v208, v84, s89, v208
v_dot2_f32_bf16 v209, v84, s90, v209
v_dot2_f32_bf16 v210, v85, s89, v210
v_dot2_f32_bf16 v211, v85, s90, v211
v_dot2_f32_bf16 v212, v86, s89, v212
v_dot2_f32_bf16 v213, v86, s90, v213
v_dot2_f32_bf16 v214, v87, s89, v214
v_dot2_f32_bf16 v215, v87, s90, v215
s_waitcnt vmcnt(14)
s_nop 0
v_dot2_f32_bf16 v208, v88, s89, v208
v_dot2_f32_bf16 v209, v88, s90, v209
v_dot2_f32_bf16 v210, v89, s89, v210
v_dot2_f32_bf16 v211, v89, s90, v211
v_dot2_f32_bf16 v212, v90, s89, v212
v_dot2_f32_bf16 v213, v90, s90, v213
v_dot2_f32_bf16 v214, v91, s89, v214
v_dot2_f32_bf16 v215, v91, s90, v215
s_waitcnt vmcnt(13)
s_nop 0
v_dot2_f32_bf16 v208, v92, s89, v208
v_dot2_f32_bf16 v209, v92, s90, v209
v_dot2_f32_bf16 v210, v93, s89, v210
v_dot2_f32_bf16 v211, v93, s90, v211
v_dot2_f32_bf16 v212, v94, s89, v212
v_dot2_f32_bf16 v213, v94, s90, v213
v_dot2_f32_bf16 v214, v95, s89, v214
v_dot2_f32_bf16 v215, v95, s90, v215
s_waitcnt vmcnt(12)
s_nop 0
v_dot2_f32_bf16 v208, v96, s89, v208
v_dot2_f32_bf16 v209, v96, s90, v209
v_dot2_f32_bf16 v210, v97, s89, v210
v_dot2_f32_bf16 v211, v97, s90, v211
v_dot2_f32_bf16 v212, v98, s89, v212
v_dot2_f32_bf16 v213, v98, s90, v213
v_dot2_f32_bf16 v214, v99, s89, v214
v_dot2_f32_bf16 v215, v99, s90, v215
s_waitcnt vmcnt(11)
s_nop 0
v_dot2_f32_bf16 v208, v100, s89, v208
v_dot2_f32_bf16 v209, v100, s90, v209
v_dot2_f32_bf16 v210, v101, s89, v210
v_dot2_f32_bf16 v211, v101, s90, v211
v_dot2_f32_bf16 v212, v102, s89, v212
v_dot2_f32_bf16 v213, v102, s90, v213
v_dot2_f32_bf16 v214, v103, s89, v214
v_dot2_f32_bf16 v215, v103, s90, v215
s_lshl_b32 s3, s4, 11
s_add_u32 s3, s3, 36864
v_lshl_add_u32 v4, v0, 5, s3
ds_write_b128 v4, v[208:211]
ds_write_b128 v4, v[212:215] offset:16
s_waitcnt lgkmcnt(0)
s_barrier
s_cmp_lg_u32 s4, 3
s_cbranch_scc1 L_pt_now
s_cmp_ge_u32 s66, 28
s_cbranch_scc1 L_pt_now
v_lshlrev_b32 v4, 2, v0
ds_read_b32 v48, v4 offset:36864
ds_read_b32 v49, v4 offset:37120
ds_read_b32 v50, v4 offset:37376
ds_read_b32 v51, v4 offset:37632
ds_read_b32 v52, v4 offset:37888
ds_read_b32 v53, v4 offset:38144
ds_read_b32 v54, v4 offset:38400
ds_read_b32 v55, v4 offset:38656
ds_read_b32 v56, v4 offset:38912
ds_read_b32 v57, v4 offset:39168
ds_read_b32 v58, v4 offset:39424
ds_read_b32 v59, v4 offset:39680
ds_read_b32 v60, v4 offset:39936
ds_read_b32 v61, v4 offset:40192
ds_read_b32 v62, v4 offset:40448
ds_read_b32 v63, v4 offset:40704
ds_read_b32 v64, v4 offset:40960
ds_read_b32 v65, v4 offset:41216
ds_read_b32 v66, v4 offset:41472
ds_read_b32 v67, v4 offset:41728
ds_read_b32 v68, v4 offset:41984
ds_read_b32 v69, v4 offset:42240
ds_read_b32 v70, v4 offset:42496
ds_read_b32 v71, v4 offset:42752
ds_read_b32 v72, v4 offset:43008
ds_read_b32 v73, v4 offset:43264
ds_read_b32 v74, v4 offset:43520
ds_read_b32 v75, v4 offset:43776
ds_read_b32 v76, v4 offset:44032
ds_read_b32 v77, v4 offset:44288
ds_read_b32 v78, v4 offset:44544
ds_read_b32 v79, v4 offset:44800
s_waitcnt lgkmcnt(0)
v_add_f32 v48, v48, v49
v_add_f32 v50, v50, v51
v_add_f32 v52, v52, v53
v_add_f32 v54, v54, v55
v_add_f32 v56, v56, v57
v_add_f32 v58, v58, v59
v_add_f32 v60, v60, v61
v_add_f32 v62, v62, v63
v_add_f32 v64, v64, v65
v_add_f32 v66, v66, v67
v_add_f32 v68, v68, v69
v_add_f32 v70, v70, v71
v_add_f32 v72, v72, v73
v_add_f32 v74, v74, v75
v_add_f32 v76, v76, v77
v_add_f32 v78, v78, v79
v_add_f32 v48, v48, v50
v_add_f32 v52, v52, v54
v_add_f32 v56, v56, v58
v_add_f32 v60, v60, v62
v_add_f32 v64, v64, v66
v_add_f32 v68, v68, v70
v_add_f32 v72, v72, v74
v_add_f32 v76, v76, v78
v_add_f32 v48, v48, v52
v_add_f32 v56, v56, v60
v_add_f32 v64, v64, v68
v_add_f32 v72, v72, v76
v_add_f32 v48, v48, v56
v_add_f32 v64, v64, v72
v_add_f32 v48, v48, v64
v_mov_b32 v49, v40
s_lshl_b32 s3, s66, 9
s_add_u32 s3, s3, 0x1118000
v_lshl_add_u32 v4, v0, 3, s3
global_store_dwordx2 v4, v[48:49], s[44:45] sc1
L_pt_now:
s_cmp_ge_u32 s65, 98
s_cbranch_scc1 L_pt_end
s_waitcnt vmcnt(8)
v_lshlrev_b32 v24, 16, v24
v_lshlrev_b32 v25, 16, v25
v_lshlrev_b32 v26, 16, v26
v_mul_f32 v26, 0x3fb8aa3b, v26
v_exp_f32 v26, v26
s_nop 0
v_cvt_pk_bf16_f32 v26, v26, v26
v_and_b32 v26, 0xffff0000, v26
v_mul_f32 v44, v24, v26
v_mul_f32 v45, v25, v26
v_mul_f32 v44, 0x3fb8aa3b, v44
v_mul_f32 v45, 0x3e22f983, v45
v_exp_f32 v43, v44
v_fract_f32 v47, v45
v_cos_f32 v46, v47
v_sin_f32 v47, v47
v_mul_f32 v46, v46, v43
v_mul_f32 v47, v47, v43
v_add_f32 v46, -1.0, v46
v_mul_f32 v43, v24, v24
v_fmac_f32 v43, v25, v25
v_rcp_f32 v43, v43
v_mul_f32 v44, v46, v24
v_fmac_f32 v44, v47, v25
v_mul_f32 v45, v47, v24
v_fma_f32 v45, -v46, v25, v45
v_add_f32 v43, v43, v43
v_mul_f32 v44, v44, v43
v_mul_f32_e64 v45, v45, v43
ds_write_b64 v21, v[44:45] offset:8192
s_waitcnt vmcnt(0)
ds_read_b64 v[48:49], v160
ds_read_b64 v[50:51], v160 offset:4096
ds_read_b128 v[80:83], v22 offset:8192
ds_read_b128 v[84:87], v22 offset:8208
ds_read_b64 v[52:53], v161
ds_read_b64 v[54:55], v161 offset:4096
ds_read_b128 v[88:91], v22 offset:8256
ds_read_b128 v[92:95], v22 offset:8272
ds_read_b64 v[56:57], v162
ds_read_b64 v[58:59], v162 offset:4096
ds_read_b128 v[96:99], v22 offset:8320
ds_read_b128 v[100:103], v22 offset:8336
ds_read_b64 v[60:61], v163
ds_read_b64 v[62:63], v163 offset:4096
ds_read_b128 v[104:107], v22 offset:8384
ds_read_b128 v[108:111], v22 offset:8400
ds_read_b64 v[64:65], v164
ds_read_b64 v[66:67], v164 offset:4096
ds_read_b128 v[112:115], v22 offset:8448
ds_read_b128 v[116:119], v22 offset:8464
ds_read_b64 v[68:69], v165
ds_read_b64 v[70:71], v165 offset:4096
ds_read_b128 v[120:123], v22 offset:8512
ds_read_b128 v[124:127], v22 offset:8528
ds_read_b64 v[72:73], v166
ds_read_b64 v[74:75], v166 offset:4096
ds_read_b128 v[128:131], v22 offset:8576
ds_read_b128 v[132:135], v22 offset:8592
ds_read_b64 v[76:77], v167
ds_read_b64 v[78:79], v167 offset:4096
ds_read_b128 v[136:139], v22 offset:8640
ds_read_b128 v[140:143], v22 offset:8656
s_waitcnt lgkmcnt(15)
v_lshlrev_b32 v168, 16, v48
v_lshlrev_b32_e64 v169, 16, v50
v_pk_mul_f32 v[170:171], v[168:169], v[80:81] op_sel_hi:[1,0] neg_hi:[1,0]
v_pk_fma_f32 v[170:171], v[168:169], v[80:81], v[170:171] op_sel:[1,1,0] op_sel_hi:[0,1,1] neg_lo:[1,0,0] neg_hi:[1,0,0]
v_cvt_pk_bf16_f32 v144, v170, v171
v_and_b32 v168, 0xffff0000, v48
v_and_b32 v169, 0xffff0000, v50
v_pk_mul_f32 v[170:171], v[168:169], v[82:83] op_sel_hi:[1,0] neg_hi:[1,0]
v_pk_fma_f32 v[170:171], v[168:169], v[82:83], v[170:171] op_sel:[1,1,0] op_sel_hi:[0,1,1] neg_lo:[1,0,0] neg_hi:[1,0,0]
v_cvt_pk_bf16_f32 v145, v170, v171
v_lshlrev_b32 v168, 16, v49
v_lshlrev_b32 v169, 16, v51
v_pk_mul_f32 v[170:171], v[168:169], v[84:85] op_sel_hi:[1,0] neg_hi:[1,0]
v_pk_fma_f32 v[170:171], v[168:169], v[84:85], v[170:171] op_sel:[1,1,0] op_sel_hi:[0,1,1] neg_lo:[1,0,0] neg_hi:[1,0,0]
v_cvt_pk_bf16_f32 v146, v170, v171
v_and_b32 v168, 0xffff0000, v49
v_and_b32 v169, 0xffff0000, v51
v_pk_mul_f32 v[170:171], v[168:169], v[86:87] op_sel_hi:[1,0] neg_hi:[1,0]
v_pk_fma_f32 v[170:171], v[168:169], v[86:87], v[170:171] op_sel:[1,1,0] op_sel_hi:[0,1,1] neg_lo:[1,0,0] neg_hi:[1,0,0]
v_cvt_pk_bf16_f32 v147, v170, v171
s_add_u32 s12, s11, 0
buffer_store_dwordx4 v[144:147], v19, s[76:79], s12 offen sc1
v_lshlrev_b32 v168, 16, v52
v_lshlrev_b32_e64 v169, 16, v54
v_pk_mul_f32 v[170:171], v[168:169], v[88:89] op_sel_hi:[1,0] neg_hi:[1,0]
v_pk_fma_f32 v[170:171], v[168:169], v[88:89], v[170:171] op_sel:[1,1,0] op_sel_hi:[0,1,1] neg_lo:[1,0,0] neg_hi:[1,0,0]
v_cvt_pk_bf16_f32 v148, v170, v171
v_and_b32 v168, 0xffff0000, v52
v_and_b32 v169, 0xffff0000, v54
v_pk_mul_f32 v[170:171], v[168:169], v[90:91] op_sel_hi:[1,0] neg_hi:[1,0]
v_pk_fma_f32 v[170:171], v[168:169], v[90:91], v[170:171] op_sel:[1,1,0] op_sel_hi:[0,1,1] neg_lo:[1,0,0] neg_hi:[1,0,0]
v_cvt_pk_bf16_f32 v149, v170, v171
v_lshlrev_b32 v168, 16, v53
v_lshlrev_b32 v169, 16, v55
v_pk_mul_f32 v[170:171], v[168:169], v[92:93] op_sel_hi:[1,0] neg_hi:[1,0]
v_pk_fma_f32 v[170:171], v[168:169], v[92:93], v[170:171] op_sel:[1,1,0] op_sel_hi:[0,1,1] neg_lo:[1,0,0] neg_hi:[1,0,0]
v_cvt_pk_bf16_f32 v150, v170, v171
v_and_b32 v168, 0xffff0000, v53
v_and_b32 v169, 0xffff0000, v55
v_pk_mul_f32 v[170:171], v[168:169], v[94:95] op_sel_hi:[1,0] neg_hi:[1,0]
v_pk_fma_f32 v[170:171], v[168:169], v[94:95], v[170:171] op_sel:[1,1,0] op_sel_hi:[0,1,1] neg_lo:[1,0,0] neg_hi:[1,0,0]
v_cvt_pk_bf16_f32 v151, v170, v171
s_add_u32 s12, s11, 57344
buffer_store_dwordx4 v[148:151], v19, s[76:79], s12 offen sc1
v_lshlrev_b32 v168, 16, v56
v_lshlrev_b32 v169, 16, v58
v_pk_mul_f32 v[170:171], v[168:169], v[96:97] op_sel_hi:[1,0] neg_hi:[1,0]
v_pk_fma_f32 v[170:171], v[168:169], v[96:97], v[170:171] op_sel:[1,1,0] op_sel_hi:[0,1,1] neg_lo:[1,0,0] neg_hi:[1,0,0]
v_cvt_pk_bf16_f32 v152, v170, v171
v_and_b32 v168, 0xffff0000, v56
v_and_b32 v169, 0xffff0000, v58
v_pk_mul_f32 v[170:171], v[168:169], v[98:99] op_sel_hi:[1,0] neg_hi:[1,0]
v_pk_fma_f32 v[170:171], v[168:169], v[98:99], v[170:171] op_sel:[1,1,0] op_sel_hi:[0,1,1] neg_lo:[1,0,0] neg_hi:[1,0,0]
v_cvt_pk_bf16_f32 v153, v170, v171
v_lshlrev_b32 v168, 16, v57
v_lshlrev_b32 v169, 16, v59
v_pk_mul_f32 v[170:171], v[168:169], v[100:101] op_sel_hi:[1,0] neg_hi:[1,0]
v_pk_fma_f32 v[170:171], v[168:169], v[100:101], v[170:171] op_sel:[1,1,0] op_sel_hi:[0,1,1] neg_lo:[1,0,0] neg_hi:[1,0,0]
v_cvt_pk_bf16_f32 v154, v170, v171
v_and_b32 v168, 0xffff0000, v57
v_and_b32 v169, 0xffff0000, v59
v_pk_mul_f32 v[170:171], v[168:169], v[102:103] op_sel_hi:[1,0] neg_hi:[1,0]
v_pk_fma_f32 v[170:171], v[168:169], v[102:103], v[170:171] op_sel:[1,1,0] op_sel_hi:[0,1,1] neg_lo:[1,0,0] neg_hi:[1,0,0]
v_cvt_pk_bf16_f32 v155, v170, v171
s_add_u32 s12, s11, 28672
buffer_store_dwordx4 v[152:155], v19, s[76:79], s12 offen sc1
v_lshlrev_b32 v168, 16, v60
v_lshlrev_b32 v169, 16, v62
v_pk_mul_f32 v[170:171], v[168:169], v[104:105] op_sel_hi:[1,0] neg_hi:[1,0]
v_pk_fma_f32 v[170:171], v[168:169], v[104:105], v[170:171] op_sel:[1,1,0] op_sel_hi:[0,1,1] neg_lo:[1,0,0] neg_hi:[1,0,0]
v_cvt_pk_bf16_f32 v156, v170, v171
v_and_b32 v168, 0xffff0000, v60
v_and_b32 v169, 0xffff0000, v62
v_pk_mul_f32 v[170:171], v[168:169], v[106:107] op_sel_hi:[1,0] neg_hi:[1,0]
v_pk_fma_f32 v[170:171], v[168:169], v[106:107], v[170:171] op_sel:[1,1,0] op_sel_hi:[0,1,1] neg_lo:[1,0,0] neg_hi:[1,0,0]
v_cvt_pk_bf16_f32 v157, v170, v171
v_lshlrev_b32 v168, 16, v61
v_lshlrev_b32 v169, 16, v63
v_pk_mul_f32 v[170:171], v[168:169], v[108:109] op_sel_hi:[1,0] neg_hi:[1,0]
v_pk_fma_f32 v[170:171], v[168:169], v[108:109], v[170:171] op_sel:[1,1,0] op_sel_hi:[0,1,1] neg_lo:[1,0,0] neg_hi:[1,0,0]
v_cvt_pk_bf16_f32 v158, v170, v171
v_and_b32 v168, 0xffff0000, v61
v_and_b32 v169, 0xffff0000, v63
v_pk_mul_f32 v[170:171], v[168:169], v[110:111] op_sel_hi:[1,0] neg_hi:[1,0]
v_pk_fma_f32 v[170:171], v[168:169], v[110:111], v[170:171] op_sel:[1,1,0] op_sel_hi:[0,1,1] neg_lo:[1,0,0] neg_hi:[1,0,0]
v_cvt_pk_bf16_f32 v159, v170, v171
s_add_u32 s12, s11, 86016
buffer_store_dwordx4 v[156:159], v19, s[76:79], s12 offen sc1
s_waitcnt lgkmcnt(12)
v_lshlrev_b32 v168, 16, v64
v_lshlrev_b32_e64 v169, 16, v66
v_pk_mul_f32 v[170:171], v[168:169], v[112:113] op_sel_hi:[1,0] neg_hi:[1,0]
v_pk_fma_f32 v[170:171], v[168:169], v[112:113], v[170:171] op_sel:[1,1,0] op_sel_hi:[0,1,1] neg_lo:[1,0,0] neg_hi:[1,0,0]
v_cvt_pk_bf16_f32 v144, v170, v171
v_and_b32 v168, 0xffff0000, v64
v_and_b32 v169, 0xffff0000, v66
v_pk_mul_f32 v[170:171], v[168:169], v[114:115] op_sel_hi:[1,0] neg_hi:[1,0]
v_pk_fma_f32 v[170:171], v[168:169], v[114:115], v[170:171] op_sel:[1,1,0] op_sel_hi:[0,1,1] neg_lo:[1,0,0] neg_hi:[1,0,0]
v_cvt_pk_bf16_f32 v145, v170, v171
v_lshlrev_b32 v168, 16, v65
v_lshlrev_b32 v169, 16, v67
v_pk_mul_f32 v[170:171], v[168:169], v[116:117] op_sel_hi:[1,0] neg_hi:[1,0]
v_pk_fma_f32 v[170:171], v[168:169], v[116:117], v[170:171] op_sel:[1,1,0] op_sel_hi:[0,1,1] neg_lo:[1,0,0] neg_hi:[1,0,0]
v_cvt_pk_bf16_f32 v146, v170, v171
v_and_b32 v168, 0xffff0000, v65
v_and_b32 v169, 0xffff0000, v67
v_pk_mul_f32 v[170:171], v[168:169], v[118:119] op_sel_hi:[1,0] neg_hi:[1,0]
v_pk_fma_f32 v[170:171], v[168:169], v[118:119], v[170:171] op_sel:[1,1,0] op_sel_hi:[0,1,1] neg_lo:[1,0,0] neg_hi:[1,0,0]
v_cvt_pk_bf16_f32 v147, v170, v171
s_add_u32 s12, s11, 2048
buffer_store_dwordx4 v[144:147], v19, s[76:79], s12 offen sc1
s_waitcnt lgkmcnt(8)
v_lshlrev_b32 v168, 16, v68
v_lshlrev_b32_e64 v169, 16, v70
v_pk_mul_f32 v[170:171], v[168:169], v[120:121] op_sel_hi:[1,0] neg_hi:[1,0]
v_pk_fma_f32 v[170:171], v[168:169], v[120:121], v[170:171] op_sel:[1,1,0] op_sel_hi:[0,1,1] neg_lo:[1,0,0] neg_hi:[1,0,0]
v_cvt_pk_bf16_f32 v148, v170, v171
v_and_b32 v168, 0xffff0000, v68
v_and_b32 v169, 0xffff0000, v70
v_pk_mul_f32 v[170:171], v[168:169], v[122:123] op_sel_hi:[1,0] neg_hi:[1,0]
v_pk_fma_f32 v[170:171], v[168:169], v[122:123], v[170:171] op_sel:[1,1,0] op_sel_hi:[0,1,1] neg_lo:[1,0,0] neg_hi:[1,0,0]
v_cvt_pk_bf16_f32 v149, v170, v171
v_lshlrev_b32 v168, 16, v69
v_lshlrev_b32 v169, 16, v71
v_pk_mul_f32 v[170:171], v[168:169], v[124:125] op_sel_hi:[1,0] neg_hi:[1,0]
v_pk_fma_f32 v[170:171], v[168:169], v[124:125], v[170:171] op_sel:[1,1,0] op_sel_hi:[0,1,1] neg_lo:[1,0,0] neg_hi:[1,0,0]
v_cvt_pk_bf16_f32 v150, v170, v171
v_and_b32 v168, 0xffff0000, v69
v_and_b32 v169, 0xffff0000, v71
v_pk_mul_f32 v[170:171], v[168:169], v[126:127] op_sel_hi:[1,0] neg_hi:[1,0]
v_pk_fma_f32 v[170:171], v[168:169], v[126:127], v[170:171] op_sel:[1,1,0] op_sel_hi:[0,1,1] neg_lo:[1,0,0] neg_hi:[1,0,0]
v_cvt_pk_bf16_f32 v151, v170, v171
s_add_u32 s12, s11, 59392
buffer_store_dwordx4 v[148:151], v19, s[76:79], s12 offen sc1
s_waitcnt lgkmcnt(4)
v_lshlrev_b32 v168, 16, v72
v_lshlrev_b32_e64 v169, 16, v74
v_pk_mul_f32 v[170:171], v[168:169], v[128:129] op_sel_hi:[1,0] neg_hi:[1,0]
v_pk_fma_f32 v[170:171], v[168:169], v[128:129], v[170:171] op_sel:[1,1,0] op_sel_hi:[0,1,1] neg_lo:[1,0,0] neg_hi:[1,0,0]
v_cvt_pk_bf16_f32 v152, v170, v171
v_and_b32 v168, 0xffff0000, v72
v_and_b32 v169, 0xffff0000, v74
v_pk_mul_f32 v[170:171], v[168:169], v[130:131] op_sel_hi:[1,0] neg_hi:[1,0]
v_pk_fma_f32 v[170:171], v[168:169], v[130:131], v[170:171] op_sel:[1,1,0] op_sel_hi:[0,1,1] neg_lo:[1,0,0] neg_hi:[1,0,0]
v_cvt_pk_bf16_f32 v153, v170, v171
v_lshlrev_b32 v168, 16, v73
v_lshlrev_b32 v169, 16, v75
v_pk_mul_f32 v[170:171], v[168:169], v[132:133] op_sel_hi:[1,0] neg_hi:[1,0]
v_pk_fma_f32 v[170:171], v[168:169], v[132:133], v[170:171] op_sel:[1,1,0] op_sel_hi:[0,1,1] neg_lo:[1,0,0] neg_hi:[1,0,0]
v_cvt_pk_bf16_f32 v154, v170, v171
v_and_b32 v168, 0xffff0000, v73
v_and_b32 v169, 0xffff0000, v75
v_pk_mul_f32 v[170:171], v[168:169], v[134:135] op_sel_hi:[1,0] neg_hi:[1,0]
v_pk_fma_f32 v[170:171], v[168:169], v[134:135], v[170:171] op_sel:[1,1,0] op_sel_hi:[0,1,1] neg_lo:[1,0,0] neg_hi:[1,0,0]
v_cvt_pk_bf16_f32 v155, v170, v171
s_add_u32 s12, s11, 30720
buffer_store_dwordx4 v[152:155], v19, s[76:79], s12 offen sc1
s_waitcnt lgkmcnt(0)
v_lshlrev_b32 v168, 16, v76
v_lshlrev_b32_e64 v169, 16, v78
v_pk_mul_f32 v[170:171], v[168:169], v[136:137] op_sel_hi:[1,0] neg_hi:[1,0]
v_pk_fma_f32 v[170:171], v[168:169], v[136:137], v[170:171] op_sel:[1,1,0] op_sel_hi:[0,1,1] neg_lo:[1,0,0] neg_hi:[1,0,0]
v_cvt_pk_bf16_f32 v156, v170, v171
v_and_b32 v168, 0xffff0000, v76
v_and_b32 v169, 0xffff0000, v78
v_pk_mul_f32 v[170:171], v[168:169], v[138:139] op_sel_hi:[1,0] neg_hi:[1,0]
v_pk_fma_f32 v[170:171], v[168:169], v[138:139], v[170:171] op_sel:[1,1,0] op_sel_hi:[0,1,1] neg_lo:[1,0,0] neg_hi:[1,0,0]
v_cvt_pk_bf16_f32 v157, v170, v171
v_lshlrev_b32 v168, 16, v77
v_lshlrev_b32 v169, 16, v79
v_pk_mul_f32 v[170:171], v[168:169], v[140:141] op_sel_hi:[1,0] neg_hi:[1,0]
v_pk_fma_f32 v[170:171], v[168:169], v[140:141], v[170:171] op_sel:[1,1,0] op_sel_hi:[0,1,1] neg_lo:[1,0,0] neg_hi:[1,0,0]
v_cvt_pk_bf16_f32 v158, v170, v171
v_and_b32 v168, 0xffff0000, v77
v_and_b32 v169, 0xffff0000, v79
v_pk_mul_f32 v[170:171], v[168:169], v[142:143] op_sel_hi:[1,0] neg_hi:[1,0]
v_pk_fma_f32 v[170:171], v[168:169], v[142:143], v[170:171] op_sel:[1,1,0] op_sel_hi:[0,1,1] neg_lo:[1,0,0] neg_hi:[1,0,0]
v_cvt_pk_bf16_f32 v159, v170, v171
s_add_u32 s12, s11, 88064
buffer_store_dwordx4 v[156:159], v19, s[76:79], s12 offen sc1
s_waitcnt vmcnt(0)
s_mov_b64 exec, 1
global_store_dword v220, v40, s[44:45] sc1
s_mov_b64 exec, -1
L_pt_end:
s_branch L_fin
L_done:
s_endpgm
L_end:
.section .rodata,"a"
.p2align 6
.amdhsa_kernel parallel_sum__ssm_conv_s5__dense_activation_silu__prompt_kernel
  .amdhsa_next_free_vgpr 512
  .amdhsa_next_free_sgpr 102
  .amdhsa_accum_offset 256
  .amdhsa_group_segment_fixed_size 0
  .amdhsa_kernarg_size 120
  .amdhsa_user_sgpr_count 2
  .amdhsa_user_sgpr_kernarg_segment_ptr 1
  .amdhsa_system_sgpr_workgroup_id_x 1
.end_amdhsa_kernel
```
